```python
import torch

def _softmax(x, axis=-1):
    return torch.softmax(x, dim=axis)
def _gelu(x):
    return torch.nn.functional.gelu(x, approximate="tanh")
def _silu(x):
    return torch.nn.functional.silu(x)
def _sigmoid(x):
    return torch.sigmoid(x)
def _layernorm(x, axis=-1, eps=1e-5):
    m = x.mean(dim=axis, keepdim=True)
    v = x.var(dim=axis, keepdim=True, unbiased=False)
    return (x - m) / torch.sqrt(v + eps)
def _scatter_add(tgt, idx, src, axis=0):
    return tgt.clone().index_add_(axis, idx, src)
def _segment_sum(src, seg, n):
    out = torch.zeros((n,) + src.shape[1:], dtype=src.dtype)
    return out.index_add_(0, seg, src)
def _pad(x, pw):
    flat = tuple(v for pair in reversed(pw) for v in pair)
    return torch.nn.functional.pad(x, flat)

kernel_name = 'standalone__gqa_block_cached__sampling'

def setup_inputs():

    _w = (lambda a: (lambda t: t.to(torch.bfloat16) if t.is_floating_point() else t)(torch.as_tensor(a)))
    B, Sq, D = 16, 1, 576
    Hq, Hkv, Sk, Dh = 32, 16, 4096, 128
    assert Hq % Hkv == 0, (Hq, Hkv)
    return {
        "x": _w((lambda *s: torch.randn(*s, dtype=torch.bfloat16) * 0.8)(B, Sq, D)),
        "k_cache": _w((lambda *s: torch.randn(*s, dtype=torch.bfloat16) * 0.8)(B, Hkv, Sk, Dh)),
        "v_cache": _w((lambda *s: torch.randn(*s, dtype=torch.bfloat16) * 0.05)(B, Hkv, Sk, Dh)),
        "wq": _w((lambda *s: torch.randn(*s, dtype=torch.bfloat16) * 0.8)(D, Hq * Dh) * (D ** -0.5)),
        "wo": _w((lambda *s: torch.randn(*s, dtype=torch.bfloat16) * 0.05)(Hq * Dh, D) * ((Hq * Dh) ** -0.5)),
    }

def reference(x, k_cache, v_cache, wq, wo):
    B, Sq, D = x.shape
    Hq, Dh = 32, 128
    Hkv = k_cache.shape[1]
    rep = Hq // Hkv
    q = (lambda x, *d: x.permute(*d))((x @ wq).reshape(B, Sq, Hq, Dh), 0, 2, 1, 3)
    k = (lambda x, n, axis: torch.repeat_interleave(x, n, dim=axis))(k_cache, rep, axis=1)
    v = (lambda x, n, axis: torch.repeat_interleave(x, n, dim=axis))(v_cache, rep, axis=1)
    scores = torch.einsum("bhqd,bhkd->bhqk", q, k) * (Dh ** -0.5)
    p = _softmax(scores, axis=-1)
    o = torch.einsum("bhqk,bhkd->bhqd", p, v)
    return (lambda x, *d: x.permute(*d))(o, 0, 2, 1, 3).reshape(B, Sq, Hq * Dh) @ wo
```

```asm
; @launch grid=(256,1,1) block=(768,1,1) lds=41216
.amdgcn_target "amdgcn-amd-amdhsa--gfx950"
.text
.globl standalone__gqa_block_cached__sampling_kernel
.p2align 8
.type standalone__gqa_block_cached__sampling_kernel,@function
standalone__gqa_block_cached__sampling_kernel:
  s_cmp_ge_u32 s2, 256
  s_cbranch_scc1 L_end
  s_load_dwordx16 s[4:19], s[0:1], 0
  v_lshrrev_b32 v1, 6, v0
  v_and_b32 v0, 63, v0
  s_and_b32 s20, s2, 7
  v_readfirstlane_b32 s3, v1
  s_lshl_b32 s20, s20, 1
  s_bfe_u32 s21, s2, 0x10003
  s_add_u32 s20, s20, s21
  s_lshr_b32 s21, s2, 4
  s_mov_b32 s27, 0x20000
  s_mov_b32 s40, 0x3e0293ee
  s_cmp_lg_u32 s3, 0
  s_cbranch_scc1 L_notq
L_qwave:
  s_setprio 3
  v_and_b32 v2, 15, v0
  v_lshrrev_b32 v3, 4, v0
  v_lshlrev_b32 v4, 3, v2
  v_lshl_add_u32 v5, v3, 15, v4
  v_lshl_add_u32 v4, v3, 16, v4
  v_mul_u32_u24 v6, 1152, v2
  v_lshl_add_u32 v7, v3, 3, v6
  v_lshl_add_u32 v6, v3, 4, v6
  s_lshr_b32 s36, s21, 2
  s_and_b32 s37, s21, 3
  s_mul_i32 s38, s36, 1179648
  s_lshl_b32 s39, s20, 9
  s_add_u32 s38, s38, s39
  s_lshl_b32 s39, s37, 7
  s_add_u32 s38, s38, s39
  s_mul_i32 s39, s36, 288
  s_sub_u32 s26, 4718592, s38
  s_sub_u32 s30, 18432, s39
  s_mov_b32 s31, 0x20000
  s_mov_b32 s41, 0
  s_movk_i32 s48, 8192
  s_mov_b32 s3, 4
  s_mov_b32 s23, 0
  s_waitcnt lgkmcnt(0)
  s_add_u32 s24, s10, s38
  s_addc_u32 s25, s11, 0
  s_add_u32 s28, s4, s39
  s_addc_u32 s29, s5, 0
  buffer_load_dwordx4 v[24:27], v6, s[28:31], 0 offen offset:0
  buffer_load_dwordx2 v[44:45], v4, s[24:27], s41 offen nt
  s_add_u32 s41, s41, s48
  buffer_load_dwordx2 v[46:47], v4, s[24:27], s41 offen nt
  s_add_u32 s41, s41, s48
  buffer_load_dwordx2 v[48:49], v4, s[24:27], s41 offen nt
  s_add_u32 s41, s41, s48
  buffer_load_dwordx2 v[50:51], v4, s[24:27], s41 offen nt
  s_add_u32 s41, s41, s48
  buffer_load_dwordx2 v[52:53], v4, s[24:27], s41 offen nt
  s_add_u32 s41, s41, s48
  buffer_load_dwordx2 v[54:55], v4, s[24:27], s41 offen nt
  s_add_u32 s41, s41, s48
  buffer_load_dwordx2 v[56:57], v4, s[24:27], s41 offen nt
  s_add_u32 s41, s41, s48
  buffer_load_dwordx2 v[58:59], v4, s[24:27], s41 offen nt
  s_add_u32 s41, s41, 204800
  buffer_load_dwordx4 v[28:31], v6, s[28:31], 0 offen offset:64
  buffer_load_dwordx2 v[60:61], v4, s[24:27], s41 offen nt
  s_add_u32 s41, s41, s48
  buffer_load_dwordx2 v[62:63], v4, s[24:27], s41 offen nt
  s_add_u32 s41, s41, s48
  buffer_load_dwordx2 v[64:65], v4, s[24:27], s41 offen nt
  s_add_u32 s41, s41, s48
  buffer_load_dwordx2 v[66:67], v4, s[24:27], s41 offen nt
  s_add_u32 s41, s41, s48
  buffer_load_dwordx2 v[68:69], v4, s[24:27], s41 offen nt
  s_add_u32 s41, s41, s48
  buffer_load_dwordx2 v[70:71], v4, s[24:27], s41 offen nt
  s_add_u32 s41, s41, s48
  buffer_load_dwordx2 v[72:73], v4, s[24:27], s41 offen nt
  s_add_u32 s41, s41, s48
  buffer_load_dwordx2 v[74:75], v4, s[24:27], s41 offen nt
  s_add_u32 s41, s41, 204800
  buffer_load_dwordx4 v[32:35], v6, s[28:31], 0 offen offset:128
  buffer_load_dwordx2 v[76:77], v4, s[24:27], s41 offen nt
  s_add_u32 s41, s41, s48
  buffer_load_dwordx2 v[78:79], v4, s[24:27], s41 offen nt
  s_add_u32 s41, s41, s48
  buffer_load_dwordx2 v[80:81], v4, s[24:27], s41 offen nt
  s_add_u32 s41, s41, s48
  buffer_load_dwordx2 v[82:83], v4, s[24:27], s41 offen nt
  s_add_u32 s41, s41, s48
  buffer_load_dwordx2 v[84:85], v4, s[24:27], s41 offen nt
  s_add_u32 s41, s41, s48
  buffer_load_dwordx2 v[86:87], v4, s[24:27], s41 offen nt
  s_add_u32 s41, s41, s48
  buffer_load_dwordx2 v[88:89], v4, s[24:27], s41 offen nt
  s_add_u32 s41, s41, s48
  buffer_load_dwordx2 v[90:91], v4, s[24:27], s41 offen nt
  s_add_u32 s41, s41, 204800
  buffer_load_dwordx4 v[36:39], v6, s[28:31], 0 offen offset:192
  buffer_load_dwordx2 v[92:93], v4, s[24:27], s41 offen nt
  s_add_u32 s41, s41, s48
  buffer_load_dwordx2 v[94:95], v4, s[24:27], s41 offen nt
  s_add_u32 s41, s41, s48
  buffer_load_dwordx2 v[96:97], v4, s[24:27], s41 offen nt
  s_add_u32 s41, s41, s48
  buffer_load_dwordx2 v[98:99], v4, s[24:27], s41 offen nt
  s_add_u32 s41, s41, s48
  buffer_load_dwordx2 v[100:101], v4, s[24:27], s41 offen nt
  s_add_u32 s41, s41, s48
  buffer_load_dwordx2 v[102:103], v4, s[24:27], s41 offen nt
  s_add_u32 s41, s41, s48
  buffer_load_dwordx2 v[104:105], v4, s[24:27], s41 offen nt
  s_add_u32 s41, s41, s48
  buffer_load_dwordx2 v[106:107], v4, s[24:27], s41 offen nt
  s_add_u32 s41, s41, 204800
  buffer_load_dwordx2 v[40:41], v7, s[28:31], 0 offen offset:256
  buffer_load_dwordx2 v[108:109], v5, s[24:27], s41 offen nt
  s_add_u32 s41, s41, s48
  buffer_load_dwordx2 v[110:111], v5, s[24:27], s41 offen nt
  s_add_u32 s41, s41, s48
  buffer_load_dwordx2 v[112:113], v5, s[24:27], s41 offen nt
  s_add_u32 s41, s41, s48
  buffer_load_dwordx2 v[114:115], v5, s[24:27], s41 offen nt
  s_branch L_q2
L_notq:
  s_cmp_ge_u32 s3, 5
  s_cbranch_scc1 L_helper
  s_sub_u32 s3, s3, 1
  s_lshl_b32 s22, s21, 4
  s_add_u32 s22, s22, s20
  s_setprio 3
  s_and_b32 s36, s3, 1
  s_lshl_b32 s36, s36, 13
  s_lshr_b32 s37, s3, 1
  s_lshl_b32 s37, s37, 15
  s_add_u32 s36, s36, s37
  v_bfe_u32 v3, v0, 2, 2
  v_lshlrev_b32 v1, 8, v3
  v_lshrrev_b32 v3, 4, v0
  v_lshl_add_u32 v1, v3, 6, v1
  v_and_b32 v3, 3, v0
  v_lshl_add_u32 v1, v3, 4, v1
  s_lshl_b32 s23, s22, 20
  s_mov_b32 s26, 0x100000
  s_add_u32 s37, s36, 4096
  s_waitcnt lgkmcnt(0)
  s_add_u32 s24, s6, s23
  s_addc_u32 s25, s7, 0
  buffer_load_dwordx4 v[40:43], v1, s[24:27], s36 offen offset:0 nt
  buffer_load_dwordx4 v[44:47], v1, s[24:27], s36 offen offset:1024 nt
  buffer_load_dwordx4 v[48:51], v1, s[24:27], s36 offen offset:2048 nt
  buffer_load_dwordx4 v[52:55], v1, s[24:27], s36 offen offset:3072 nt
  buffer_load_dwordx4 v[56:59], v1, s[24:27], s37 offen offset:0 nt
  s_add_u32 s38, s36, 16384
  s_add_u32 s39, s36, 20480
  s_add_u32 s52, s36, 65536
  s_add_u32 s53, s36, 69632
  s_add_u32 s54, s36, 81920
  s_add_u32 s55, s36, 86016
  s_mov_b32 s58, s36
  v_and_b32 v3, 15, v0
  v_lshlrev_b32 v2, 4, v3
  v_bfe_u32 v3, v0, 4, 1
  v_lshl_add_u32 v2, v3, 8, v2
  v_lshrrev_b32 v3, 5, v0
  v_lshl_add_u32 v2, v3, 9, v2
  s_mov_b32 s59, 0
  s_add_u32 s28, s8, s23
  s_addc_u32 s29, s9, 0
  v_bfe_u32 v3, v0, 2, 1
  v_cmp_eq_u32 vcc, 0, v3
  v_mov_b32 v5, 0xffff
  v_and_b32 v3, 3, v0
  v_mul_u32_u24 v25, 0x5555, v3
  v_cndmask_b32 v32, 0, v5, vcc
  v_xor_b32 v33, v32, v5
  v_lshlrev_b32 v34, 16, v32
  v_lshlrev_b32 v35, 16, v33
  v_bfe_u32 v5, v0, 3, 1
  v_lshlrev_b32 v38, 8, v5
  v_lshrrev_b32 v6, 4, v0
  v_lshl_add_u32 v38, v6, 6, v38
  v_and_b32 v3, 3, v0
  v_lshl_add_u32 v38, v3, 4, v38
  s_mul_i32 s56, s3, 1168
  s_add_u32 s56, s56, 1024
  v_and_b32 v3, 15, v0
  v_lshl_add_u32 v4, v3, 5, s56
  v_bfe_u32 v3, v0, 4, 1
  v_lshl_add_u32 v4, v3, 4, v4
  v_lshrrev_b32 v3, 5, v0
  v_lshl_add_u32 v4, v3, 9, v4
  s_lshl_b32 s56, s3, 13
  v_lshl_add_u32 v26, v0, 2, s56
  v_mov_b32 v3, 0xff7fffff
  v_mov_b32 v28, 0
  v_mov_b32 v29, 0
  v_mov_b32 v30, 0
  v_mov_b32 v31, 0
  v_mov_b32 v39, 0
  s_lshl_b32 s56, s3, 2
  v_mov_b32 v36, s56
  v_mov_b32 v27, 0
  s_mov_b32 s41, 0
  s_lshl_b32 s44, s21, 16
  s_add_u32 s44, s44, 3145728
  s_add_u32 s44, s18, s44
  s_addc_u32 s45, s19, 0
  s_mov_b32 s46, 0xc000
  s_mov_b32 s47, 0x20000
  s_mul_i32 s48, s21, 1152
  s_add_u32 s48, s14, s48
  s_addc_u32 s49, s15, 0
  s_mov_b32 s50, 1152
  s_mov_b32 s51, 0x20000
  s_lshl_b32 s43, s21, 4
  s_mov_b32 s32, s16
  s_mov_b32 s33, s17
  s_cmp_eq_u32 s3, 1
  s_cselect_b32 s34, 256, 0
  s_mov_b32 s35, 0x20000
  s_mov_b32 s56, 0x02020202
  s_mov_b32 s57, 0x02020202
  s_mov_b32 s22, 0
  s_waitcnt vmcnt(4)
  buffer_load_dwordx4 v[60:63], v1, s[24:27], s37 offen offset:1024 nt
  s_waitcnt vmcnt(4)
  buffer_load_dwordx4 v[64:67], v1, s[24:27], s37 offen offset:2048 nt
  s_waitcnt vmcnt(4)
  buffer_load_dwordx4 v[68:71], v1, s[24:27], s37 offen offset:3072 nt
  s_waitcnt vmcnt(4)
  buffer_load_dwordx4 v[72:75], v1, s[24:27], s38 offen offset:0 nt
  s_waitcnt vmcnt(4)
  buffer_load_dwordx4 v[76:79], v1, s[24:27], s38 offen offset:1024 nt
  s_waitcnt vmcnt(4)
  buffer_load_dwordx4 v[80:83], v1, s[24:27], s38 offen offset:2048 nt
  s_waitcnt vmcnt(4)
  buffer_load_dwordx4 v[84:87], v1, s[24:27], s38 offen offset:3072 nt
  s_waitcnt vmcnt(4)
  buffer_load_dwordx4 v[88:91], v1, s[24:27], s39 offen offset:0 nt
  s_waitcnt vmcnt(4)
  buffer_load_dwordx4 v[92:95], v1, s[24:27], s39 offen offset:1024 nt
  s_waitcnt vmcnt(4)
  buffer_load_dwordx4 v[96:99], v1, s[24:27], s39 offen offset:2048 nt
  s_waitcnt vmcnt(4)
  buffer_load_dwordx4 v[100:103], v1, s[24:27], s39 offen offset:3072 nt
  s_waitcnt vmcnt(4)
  buffer_load_dwordx4 v[104:107], v1, s[24:27], s52 offen offset:0 nt
  s_waitcnt vmcnt(4)
  buffer_load_dwordx4 v[108:111], v1, s[24:27], s52 offen offset:1024 nt
  s_waitcnt vmcnt(4)
  buffer_load_dwordx4 v[112:115], v1, s[24:27], s52 offen offset:2048 nt
  s_waitcnt vmcnt(4)
  buffer_load_dwordx4 v[116:119], v1, s[24:27], s52 offen offset:3072 nt
  s_waitcnt vmcnt(4)
  buffer_load_dwordx4 v[120:123], v1, s[24:27], s53 offen offset:0 nt
  s_waitcnt vmcnt(4)
  buffer_load_dwordx4 v[124:127], v1, s[24:27], s53 offen offset:1024 nt
  s_waitcnt vmcnt(4)
  buffer_load_dwordx4 v[128:131], v1, s[24:27], s53 offen offset:2048 nt
  s_waitcnt vmcnt(4)
  buffer_load_dwordx4 v[132:135], v1, s[24:27], s53 offen offset:3072 nt
  s_waitcnt vmcnt(4)
  buffer_load_dwordx4 v[136:139], v1, s[24:27], s54 offen offset:0 nt
  s_waitcnt vmcnt(4)
  buffer_load_dwordx4 v[140:143], v1, s[24:27], s54 offen offset:1024 nt
  s_waitcnt vmcnt(4)
  buffer_load_dwordx4 v[144:147], v1, s[24:27], s54 offen offset:2048 nt
  s_waitcnt vmcnt(4)
  buffer_load_dwordx4 v[148:151], v1, s[24:27], s54 offen offset:3072 nt
  s_waitcnt vmcnt(4)
  buffer_load_dwordx4 v[152:155], v1, s[24:27], s55 offen offset:0 nt
  s_waitcnt vmcnt(4)
  buffer_load_dwordx4 v[156:159], v1, s[24:27], s55 offen offset:1024 nt
  s_waitcnt vmcnt(4)
  buffer_load_dwordx4 v[160:163], v1, s[24:27], s55 offen offset:2048 nt
  s_waitcnt vmcnt(4)
  buffer_load_dwordx4 v[164:167], v1, s[24:27], s55 offen offset:3072 nt
  s_barrier
  ds_read_b128 v[8:11], v38 offset:0
  ds_read_b32 v39, v39 offset:512
  s_waitcnt lgkmcnt(0)
L_kloop:
  s_or_b32 s59, s59, 0xfff1ffff
  s_add_u32 s59, s59, 1
  s_and_b32 s59, s59, 0xe0000
  s_add_u32 s36, s59, s58
  s_add_u32 s37, s36, 4096
  s_add_u32 s38, s36, 16384
  s_add_u32 s39, s36, 20480
  s_add_u32 s52, s36, 65536
  s_add_u32 s53, s36, 69632
  s_add_u32 s54, s36, 81920
  s_add_u32 s55, s36, 86016
  s_cmp_eq_u32 s41, 7
  s_cbranch_scc0 L_ksw
  s_mov_b32 s24, s28
  s_mov_b32 s25, s29
  v_mov_b32 v1, v2
L_ksw:
  v_mfma_f32_16x16x32_bf16 v[12:15], v[40:43], v[8:11], 0
  s_waitcnt vmcnt(4)
  buffer_load_dwordx4 v[40:43], v1, s[24:27], s36 offen offset:0 nt
  v_mfma_f32_16x16x32_bf16 v[16:19], v[44:47], v[8:11], 0
  s_nop 4
  v_mov_b32_dpp v20, v12 quad_perm:[0,0,0,0] row_mask:0xf bank_mask:0xf
  s_mov_b64 s[30:31], s[56:57]
  s_nop 0
  v_add_f32_dpp v20, v13, v20 quad_perm:[1,1,1,1] row_mask:0xf bank_mask:0xf
  s_nop 1
  v_add_f32_dpp v20, v14, v20 quad_perm:[2,2,2,2] row_mask:0xf bank_mask:0xf
  s_nop 1
  v_add_f32_dpp v20, v15, v20 quad_perm:[3,3,3,3] row_mask:0xf bank_mask:0xf
  s_waitcnt vmcnt(4)
  buffer_load_dwordx4 v[44:47], v1, s[24:27], s36 offen offset:1024 nt
  v_mfma_f32_16x16x32_bf16 v[12:15], v[48:51], v[8:11], 0
  v_mov_b32_dpp v21, v16 quad_perm:[0,0,0,0] row_mask:0xf bank_mask:0xf
  s_nop 1
  v_add_f32_dpp v21, v17, v21 quad_perm:[1,1,1,1] row_mask:0xf bank_mask:0xf
  s_nop 1
  v_add_f32_dpp v21, v18, v21 quad_perm:[2,2,2,2] row_mask:0xf bank_mask:0xf
  s_nop 1
  v_add_f32_dpp v21, v19, v21 quad_perm:[3,3,3,3] row_mask:0xf bank_mask:0xf
  v_cndmask_b32 v20, v20, v21, s[30:31]
  s_waitcnt vmcnt(4)
  buffer_load_dwordx4 v[48:51], v1, s[24:27], s36 offen offset:2048 nt
  v_mfma_f32_16x16x32_bf16 v[16:19], v[52:55], v[8:11], 0
  v_mov_b32_dpp v21, v12 quad_perm:[0,0,0,0] row_mask:0xf bank_mask:0xf
  s_lshl_b64 s[30:31], s[30:31], 1
  s_nop 0
  v_add_f32_dpp v21, v13, v21 quad_perm:[1,1,1,1] row_mask:0xf bank_mask:0xf
  s_nop 1
  v_add_f32_dpp v21, v14, v21 quad_perm:[2,2,2,2] row_mask:0xf bank_mask:0xf
  s_nop 1
  v_add_f32_dpp v21, v15, v21 quad_perm:[3,3,3,3] row_mask:0xf bank_mask:0xf
  v_cndmask_b32 v20, v20, v21, s[30:31]
  s_waitcnt vmcnt(4)
  buffer_load_dwordx4 v[52:55], v1, s[24:27], s36 offen offset:3072 nt
  v_mfma_f32_16x16x32_bf16 v[12:15], v[56:59], v[8:11], 0
  v_mov_b32_dpp v21, v16 quad_perm:[0,0,0,0] row_mask:0xf bank_mask:0xf
  s_lshl_b64 s[30:31], s[30:31], 1
  s_nop 0
  v_add_f32_dpp v21, v17, v21 quad_perm:[1,1,1,1] row_mask:0xf bank_mask:0xf
  s_nop 1
  v_add_f32_dpp v21, v18, v21 quad_perm:[2,2,2,2] row_mask:0xf bank_mask:0xf
  s_nop 1
  v_add_f32_dpp v21, v19, v21 quad_perm:[3,3,3,3] row_mask:0xf bank_mask:0xf
  v_cndmask_b32 v20, v20, v21, s[30:31]
  s_waitcnt vmcnt(4)
  buffer_load_dwordx4 v[56:59], v1, s[24:27], s37 offen offset:0 nt
  v_mfma_f32_16x16x32_bf16 v[16:19], v[60:63], v[8:11], 0
  v_mov_b32_dpp v21, v12 quad_perm:[0,0,0,0] row_mask:0xf bank_mask:0xf
  s_lshl_b64 s[30:31], s[30:31], 1
  s_nop 0
  v_add_f32_dpp v21, v13, v21 quad_perm:[1,1,1,1] row_mask:0xf bank_mask:0xf
  s_nop 1
  v_add_f32_dpp v21, v14, v21 quad_perm:[2,2,2,2] row_mask:0xf bank_mask:0xf
  s_nop 1
  v_add_f32_dpp v21, v15, v21 quad_perm:[3,3,3,3] row_mask:0xf bank_mask:0xf
  v_cndmask_b32 v20, v20, v21, s[30:31]
  s_waitcnt vmcnt(4)
  buffer_load_dwordx4 v[60:63], v1, s[24:27], s37 offen offset:1024 nt
  v_mfma_f32_16x16x32_bf16 v[12:15], v[64:67], v[8:11], 0
  v_mov_b32_dpp v21, v16 quad_perm:[0,0,0,0] row_mask:0xf bank_mask:0xf
  s_lshl_b64 s[30:31], s[30:31], 1
  s_nop 0
  v_add_f32_dpp v21, v17, v21 quad_perm:[1,1,1,1] row_mask:0xf bank_mask:0xf
  s_nop 1
  v_add_f32_dpp v21, v18, v21 quad_perm:[2,2,2,2] row_mask:0xf bank_mask:0xf
  s_nop 1
  v_add_f32_dpp v21, v19, v21 quad_perm:[3,3,3,3] row_mask:0xf bank_mask:0xf
  v_cndmask_b32 v20, v20, v21, s[30:31]
  s_waitcnt vmcnt(4)
  buffer_load_dwordx4 v[64:67], v1, s[24:27], s37 offen offset:2048 nt
  v_mfma_f32_16x16x32_bf16 v[16:19], v[68:71], v[8:11], 0
  v_mov_b32_dpp v21, v12 quad_perm:[0,0,0,0] row_mask:0xf bank_mask:0xf
  s_lshl_b64 s[30:31], s[30:31], 1
  s_nop 0
  v_add_f32_dpp v21, v13, v21 quad_perm:[1,1,1,1] row_mask:0xf bank_mask:0xf
  s_nop 1
  v_add_f32_dpp v21, v14, v21 quad_perm:[2,2,2,2] row_mask:0xf bank_mask:0xf
  s_nop 1
  v_add_f32_dpp v21, v15, v21 quad_perm:[3,3,3,3] row_mask:0xf bank_mask:0xf
  v_cndmask_b32 v20, v20, v21, s[30:31]
  s_waitcnt vmcnt(4)
  buffer_load_dwordx4 v[68:71], v1, s[24:27], s37 offen offset:3072 nt
  v_mov_b32_dpp v21, v16 quad_perm:[0,0,0,0] row_mask:0xf bank_mask:0xf
  s_lshl_b64 s[30:31], s[30:31], 1
  s_nop 0
  v_add_f32_dpp v21, v17, v21 quad_perm:[1,1,1,1] row_mask:0xf bank_mask:0xf
  s_nop 1
  v_add_f32_dpp v21, v18, v21 quad_perm:[2,2,2,2] row_mask:0xf bank_mask:0xf
  s_nop 1
  v_add_f32_dpp v21, v19, v21 quad_perm:[3,3,3,3] row_mask:0xf bank_mask:0xf
  v_cndmask_b32 v20, v20, v21, s[30:31]
  v_max_f32 v3, v3, v20
  ds_write_b32 v26, v20 offset:8192
  v_mfma_f32_16x16x32_bf16 v[12:15], v[72:75], v[8:11], 0
  s_waitcnt vmcnt(4)
  buffer_load_dwordx4 v[72:75], v1, s[24:27], s38 offen offset:0 nt
  v_mfma_f32_16x16x32_bf16 v[16:19], v[76:79], v[8:11], 0
  s_nop 4
  v_mov_b32_dpp v20, v12 quad_perm:[0,0,0,0] row_mask:0xf bank_mask:0xf
  s_mov_b64 s[30:31], s[56:57]
  s_nop 0
  v_add_f32_dpp v20, v13, v20 quad_perm:[1,1,1,1] row_mask:0xf bank_mask:0xf
  s_nop 1
  v_add_f32_dpp v20, v14, v20 quad_perm:[2,2,2,2] row_mask:0xf bank_mask:0xf
  s_nop 1
  v_add_f32_dpp v20, v15, v20 quad_perm:[3,3,3,3] row_mask:0xf bank_mask:0xf
  s_waitcnt vmcnt(4)
  buffer_load_dwordx4 v[76:79], v1, s[24:27], s38 offen offset:1024 nt
  v_mfma_f32_16x16x32_bf16 v[12:15], v[80:83], v[8:11], 0
  v_mov_b32_dpp v21, v16 quad_perm:[0,0,0,0] row_mask:0xf bank_mask:0xf
  s_nop 1
  v_add_f32_dpp v21, v17, v21 quad_perm:[1,1,1,1] row_mask:0xf bank_mask:0xf
  s_nop 1
  v_add_f32_dpp v21, v18, v21 quad_perm:[2,2,2,2] row_mask:0xf bank_mask:0xf
  s_nop 1
  v_add_f32_dpp v21, v19, v21 quad_perm:[3,3,3,3] row_mask:0xf bank_mask:0xf
  v_cndmask_b32 v20, v20, v21, s[30:31]
  s_waitcnt vmcnt(4)
  buffer_load_dwordx4 v[80:83], v1, s[24:27], s38 offen offset:2048 nt
  v_mfma_f32_16x16x32_bf16 v[16:19], v[84:87], v[8:11], 0
  v_mov_b32_dpp v21, v12 quad_perm:[0,0,0,0] row_mask:0xf bank_mask:0xf
  s_lshl_b64 s[30:31], s[30:31], 1
  s_nop 0
  v_add_f32_dpp v21, v13, v21 quad_perm:[1,1,1,1] row_mask:0xf bank_mask:0xf
  s_nop 1
  v_add_f32_dpp v21, v14, v21 quad_perm:[2,2,2,2] row_mask:0xf bank_mask:0xf
  s_nop 1
  v_add_f32_dpp v21, v15, v21 quad_perm:[3,3,3,3] row_mask:0xf bank_mask:0xf
  v_cndmask_b32 v20, v20, v21, s[30:31]
  s_waitcnt vmcnt(4)
  buffer_load_dwordx4 v[84:87], v1, s[24:27], s38 offen offset:3072 nt
  v_mfma_f32_16x16x32_bf16 v[12:15], v[88:91], v[8:11], 0
  v_mov_b32_dpp v21, v16 quad_perm:[0,0,0,0] row_mask:0xf bank_mask:0xf
  s_lshl_b64 s[30:31], s[30:31], 1
  s_nop 0
  v_add_f32_dpp v21, v17, v21 quad_perm:[1,1,1,1] row_mask:0xf bank_mask:0xf
  s_nop 1
  v_add_f32_dpp v21, v18, v21 quad_perm:[2,2,2,2] row_mask:0xf bank_mask:0xf
  s_nop 1
  v_add_f32_dpp v21, v19, v21 quad_perm:[3,3,3,3] row_mask:0xf bank_mask:0xf
  v_cndmask_b32 v20, v20, v21, s[30:31]
  s_waitcnt vmcnt(4)
  buffer_load_dwordx4 v[88:91], v1, s[24:27], s39 offen offset:0 nt
  v_mfma_f32_16x16x32_bf16 v[16:19], v[92:95], v[8:11], 0
  v_mov_b32_dpp v21, v12 quad_perm:[0,0,0,0] row_mask:0xf bank_mask:0xf
  s_lshl_b64 s[30:31], s[30:31], 1
  s_nop 0
  v_add_f32_dpp v21, v13, v21 quad_perm:[1,1,1,1] row_mask:0xf bank_mask:0xf
  s_nop 1
  v_add_f32_dpp v21, v14, v21 quad_perm:[2,2,2,2] row_mask:0xf bank_mask:0xf
  s_nop 1
  v_add_f32_dpp v21, v15, v21 quad_perm:[3,3,3,3] row_mask:0xf bank_mask:0xf
  v_cndmask_b32 v20, v20, v21, s[30:31]
  s_waitcnt vmcnt(4)
  buffer_load_dwordx4 v[92:95], v1, s[24:27], s39 offen offset:1024 nt
  v_mfma_f32_16x16x32_bf16 v[12:15], v[96:99], v[8:11], 0
  v_mov_b32_dpp v21, v16 quad_perm:[0,0,0,0] row_mask:0xf bank_mask:0xf
  s_lshl_b64 s[30:31], s[30:31], 1
  s_nop 0
  v_add_f32_dpp v21, v17, v21 quad_perm:[1,1,1,1] row_mask:0xf bank_mask:0xf
  s_nop 1
  v_add_f32_dpp v21, v18, v21 quad_perm:[2,2,2,2] row_mask:0xf bank_mask:0xf
  s_nop 1
  v_add_f32_dpp v21, v19, v21 quad_perm:[3,3,3,3] row_mask:0xf bank_mask:0xf
  v_cndmask_b32 v20, v20, v21, s[30:31]
  s_waitcnt vmcnt(4)
  buffer_load_dwordx4 v[96:99], v1, s[24:27], s39 offen offset:2048 nt
  v_mfma_f32_16x16x32_bf16 v[16:19], v[100:103], v[8:11], 0
  v_mov_b32_dpp v21, v12 quad_perm:[0,0,0,0] row_mask:0xf bank_mask:0xf
  s_lshl_b64 s[30:31], s[30:31], 1
  s_nop 0
  v_add_f32_dpp v21, v13, v21 quad_perm:[1,1,1,1] row_mask:0xf bank_mask:0xf
  s_nop 1
  v_add_f32_dpp v21, v14, v21 quad_perm:[2,2,2,2] row_mask:0xf bank_mask:0xf
  s_nop 1
  v_add_f32_dpp v21, v15, v21 quad_perm:[3,3,3,3] row_mask:0xf bank_mask:0xf
  v_cndmask_b32 v20, v20, v21, s[30:31]
  s_waitcnt vmcnt(4)
  buffer_load_dwordx4 v[100:103], v1, s[24:27], s39 offen offset:3072 nt
  v_mov_b32_dpp v21, v16 quad_perm:[0,0,0,0] row_mask:0xf bank_mask:0xf
  s_lshl_b64 s[30:31], s[30:31], 1
  s_nop 0
  v_add_f32_dpp v21, v17, v21 quad_perm:[1,1,1,1] row_mask:0xf bank_mask:0xf
  s_nop 1
  v_add_f32_dpp v21, v18, v21 quad_perm:[2,2,2,2] row_mask:0xf bank_mask:0xf
  s_nop 1
  v_add_f32_dpp v21, v19, v21 quad_perm:[3,3,3,3] row_mask:0xf bank_mask:0xf
  v_cndmask_b32 v20, v20, v21, s[30:31]
  v_max_f32 v3, v3, v20
  ds_write_b32 v26, v20 offset:8448
  v_mfma_f32_16x16x32_bf16 v[12:15], v[104:107], v[8:11], 0
  s_waitcnt vmcnt(4)
  buffer_load_dwordx4 v[104:107], v1, s[24:27], s52 offen offset:0 nt
  v_mfma_f32_16x16x32_bf16 v[16:19], v[108:111], v[8:11], 0
  s_nop 4
  v_mov_b32_dpp v20, v12 quad_perm:[0,0,0,0] row_mask:0xf bank_mask:0xf
  s_mov_b64 s[30:31], s[56:57]
  s_nop 0
  v_add_f32_dpp v20, v13, v20 quad_perm:[1,1,1,1] row_mask:0xf bank_mask:0xf
  s_nop 1
  v_add_f32_dpp v20, v14, v20 quad_perm:[2,2,2,2] row_mask:0xf bank_mask:0xf
  s_nop 1
  v_add_f32_dpp v20, v15, v20 quad_perm:[3,3,3,3] row_mask:0xf bank_mask:0xf
  s_waitcnt vmcnt(4)
  buffer_load_dwordx4 v[108:111], v1, s[24:27], s52 offen offset:1024 nt
  v_mfma_f32_16x16x32_bf16 v[12:15], v[112:115], v[8:11], 0
  v_mov_b32_dpp v21, v16 quad_perm:[0,0,0,0] row_mask:0xf bank_mask:0xf
  s_nop 1
  v_add_f32_dpp v21, v17, v21 quad_perm:[1,1,1,1] row_mask:0xf bank_mask:0xf
  s_nop 1
  v_add_f32_dpp v21, v18, v21 quad_perm:[2,2,2,2] row_mask:0xf bank_mask:0xf
  s_nop 1
  v_add_f32_dpp v21, v19, v21 quad_perm:[3,3,3,3] row_mask:0xf bank_mask:0xf
  v_cndmask_b32 v20, v20, v21, s[30:31]
  s_waitcnt vmcnt(4)
  buffer_load_dwordx4 v[112:115], v1, s[24:27], s52 offen offset:2048 nt
  v_mfma_f32_16x16x32_bf16 v[16:19], v[116:119], v[8:11], 0
  v_mov_b32_dpp v21, v12 quad_perm:[0,0,0,0] row_mask:0xf bank_mask:0xf
  s_lshl_b64 s[30:31], s[30:31], 1
  s_nop 0
  v_add_f32_dpp v21, v13, v21 quad_perm:[1,1,1,1] row_mask:0xf bank_mask:0xf
  s_nop 1
  v_add_f32_dpp v21, v14, v21 quad_perm:[2,2,2,2] row_mask:0xf bank_mask:0xf
  s_nop 1
  v_add_f32_dpp v21, v15, v21 quad_perm:[3,3,3,3] row_mask:0xf bank_mask:0xf
  v_cndmask_b32 v20, v20, v21, s[30:31]
  s_waitcnt vmcnt(4)
  buffer_load_dwordx4 v[116:119], v1, s[24:27], s52 offen offset:3072 nt
  v_mfma_f32_16x16x32_bf16 v[12:15], v[120:123], v[8:11], 0
  v_mov_b32_dpp v21, v16 quad_perm:[0,0,0,0] row_mask:0xf bank_mask:0xf
  s_lshl_b64 s[30:31], s[30:31], 1
  s_nop 0
  v_add_f32_dpp v21, v17, v21 quad_perm:[1,1,1,1] row_mask:0xf bank_mask:0xf
  s_nop 1
  v_add_f32_dpp v21, v18, v21 quad_perm:[2,2,2,2] row_mask:0xf bank_mask:0xf
  s_nop 1
  v_add_f32_dpp v21, v19, v21 quad_perm:[3,3,3,3] row_mask:0xf bank_mask:0xf
  v_cndmask_b32 v20, v20, v21, s[30:31]
  s_waitcnt vmcnt(4)
  buffer_load_dwordx4 v[120:123], v1, s[24:27], s53 offen offset:0 nt
  v_mfma_f32_16x16x32_bf16 v[16:19], v[124:127], v[8:11], 0
  v_mov_b32_dpp v21, v12 quad_perm:[0,0,0,0] row_mask:0xf bank_mask:0xf
  s_lshl_b64 s[30:31], s[30:31], 1
  s_nop 0
  v_add_f32_dpp v21, v13, v21 quad_perm:[1,1,1,1] row_mask:0xf bank_mask:0xf
  s_nop 1
  v_add_f32_dpp v21, v14, v21 quad_perm:[2,2,2,2] row_mask:0xf bank_mask:0xf
  s_nop 1
  v_add_f32_dpp v21, v15, v21 quad_perm:[3,3,3,3] row_mask:0xf bank_mask:0xf
  v_cndmask_b32 v20, v20, v21, s[30:31]
  s_waitcnt vmcnt(4)
  buffer_load_dwordx4 v[124:127], v1, s[24:27], s53 offen offset:1024 nt
  v_mfma_f32_16x16x32_bf16 v[12:15], v[128:131], v[8:11], 0
  v_mov_b32_dpp v21, v16 quad_perm:[0,0,0,0] row_mask:0xf bank_mask:0xf
  s_lshl_b64 s[30:31], s[30:31], 1
  s_nop 0
  v_add_f32_dpp v21, v17, v21 quad_perm:[1,1,1,1] row_mask:0xf bank_mask:0xf
  s_nop 1
  v_add_f32_dpp v21, v18, v21 quad_perm:[2,2,2,2] row_mask:0xf bank_mask:0xf
  s_nop 1
  v_add_f32_dpp v21, v19, v21 quad_perm:[3,3,3,3] row_mask:0xf bank_mask:0xf
  v_cndmask_b32 v20, v20, v21, s[30:31]
  s_waitcnt vmcnt(4)
  buffer_load_dwordx4 v[128:131], v1, s[24:27], s53 offen offset:2048 nt
  v_mfma_f32_16x16x32_bf16 v[16:19], v[132:135], v[8:11], 0
  v_mov_b32_dpp v21, v12 quad_perm:[0,0,0,0] row_mask:0xf bank_mask:0xf
  s_lshl_b64 s[30:31], s[30:31], 1
  s_nop 0
  v_add_f32_dpp v21, v13, v21 quad_perm:[1,1,1,1] row_mask:0xf bank_mask:0xf
  s_nop 1
  v_add_f32_dpp v21, v14, v21 quad_perm:[2,2,2,2] row_mask:0xf bank_mask:0xf
  s_nop 1
  v_add_f32_dpp v21, v15, v21 quad_perm:[3,3,3,3] row_mask:0xf bank_mask:0xf
  v_cndmask_b32 v20, v20, v21, s[30:31]
  s_waitcnt vmcnt(4)
  buffer_load_dwordx4 v[132:135], v1, s[24:27], s53 offen offset:3072 nt
  v_mov_b32_dpp v21, v16 quad_perm:[0,0,0,0] row_mask:0xf bank_mask:0xf
  s_lshl_b64 s[30:31], s[30:31], 1
  s_nop 0
  v_add_f32_dpp v21, v17, v21 quad_perm:[1,1,1,1] row_mask:0xf bank_mask:0xf
  s_nop 1
  v_add_f32_dpp v21, v18, v21 quad_perm:[2,2,2,2] row_mask:0xf bank_mask:0xf
  s_nop 1
  v_add_f32_dpp v21, v19, v21 quad_perm:[3,3,3,3] row_mask:0xf bank_mask:0xf
  v_cndmask_b32 v20, v20, v21, s[30:31]
  v_max_f32 v3, v3, v20
  ds_write_b32 v26, v20 offset:8704
  v_mfma_f32_16x16x32_bf16 v[12:15], v[136:139], v[8:11], 0
  s_waitcnt vmcnt(4)
  buffer_load_dwordx4 v[136:139], v1, s[24:27], s54 offen offset:0 nt
  v_mfma_f32_16x16x32_bf16 v[16:19], v[140:143], v[8:11], 0
  s_nop 4
  v_mov_b32_dpp v20, v12 quad_perm:[0,0,0,0] row_mask:0xf bank_mask:0xf
  s_mov_b64 s[30:31], s[56:57]
  s_nop 0
  v_add_f32_dpp v20, v13, v20 quad_perm:[1,1,1,1] row_mask:0xf bank_mask:0xf
  s_nop 1
  v_add_f32_dpp v20, v14, v20 quad_perm:[2,2,2,2] row_mask:0xf bank_mask:0xf
  s_nop 1
  v_add_f32_dpp v20, v15, v20 quad_perm:[3,3,3,3] row_mask:0xf bank_mask:0xf
  s_waitcnt vmcnt(4)
  buffer_load_dwordx4 v[140:143], v1, s[24:27], s54 offen offset:1024 nt
  v_mfma_f32_16x16x32_bf16 v[12:15], v[144:147], v[8:11], 0
  v_mov_b32_dpp v21, v16 quad_perm:[0,0,0,0] row_mask:0xf bank_mask:0xf
  s_nop 1
  v_add_f32_dpp v21, v17, v21 quad_perm:[1,1,1,1] row_mask:0xf bank_mask:0xf
  s_nop 1
  v_add_f32_dpp v21, v18, v21 quad_perm:[2,2,2,2] row_mask:0xf bank_mask:0xf
  s_nop 1
  v_add_f32_dpp v21, v19, v21 quad_perm:[3,3,3,3] row_mask:0xf bank_mask:0xf
  v_cndmask_b32 v20, v20, v21, s[30:31]
  s_waitcnt vmcnt(4)
  buffer_load_dwordx4 v[144:147], v1, s[24:27], s54 offen offset:2048 nt
  v_mfma_f32_16x16x32_bf16 v[16:19], v[148:151], v[8:11], 0
  v_mov_b32_dpp v21, v12 quad_perm:[0,0,0,0] row_mask:0xf bank_mask:0xf
  s_lshl_b64 s[30:31], s[30:31], 1
  s_nop 0
  v_add_f32_dpp v21, v13, v21 quad_perm:[1,1,1,1] row_mask:0xf bank_mask:0xf
  s_nop 1
  v_add_f32_dpp v21, v14, v21 quad_perm:[2,2,2,2] row_mask:0xf bank_mask:0xf
  s_nop 1
  v_add_f32_dpp v21, v15, v21 quad_perm:[3,3,3,3] row_mask:0xf bank_mask:0xf
  v_cndmask_b32 v20, v20, v21, s[30:31]
  s_waitcnt vmcnt(4)
  buffer_load_dwordx4 v[148:151], v1, s[24:27], s54 offen offset:3072 nt
  v_mfma_f32_16x16x32_bf16 v[12:15], v[152:155], v[8:11], 0
  v_mov_b32_dpp v21, v16 quad_perm:[0,0,0,0] row_mask:0xf bank_mask:0xf
  s_lshl_b64 s[30:31], s[30:31], 1
  s_nop 0
  v_add_f32_dpp v21, v17, v21 quad_perm:[1,1,1,1] row_mask:0xf bank_mask:0xf
  s_nop 1
  v_add_f32_dpp v21, v18, v21 quad_perm:[2,2,2,2] row_mask:0xf bank_mask:0xf
  s_nop 1
  v_add_f32_dpp v21, v19, v21 quad_perm:[3,3,3,3] row_mask:0xf bank_mask:0xf
  v_cndmask_b32 v20, v20, v21, s[30:31]
  s_waitcnt vmcnt(4)
  buffer_load_dwordx4 v[152:155], v1, s[24:27], s55 offen offset:0 nt
  v_mfma_f32_16x16x32_bf16 v[16:19], v[156:159], v[8:11], 0
  v_mov_b32_dpp v21, v12 quad_perm:[0,0,0,0] row_mask:0xf bank_mask:0xf
  s_lshl_b64 s[30:31], s[30:31], 1
  s_nop 0
  v_add_f32_dpp v21, v13, v21 quad_perm:[1,1,1,1] row_mask:0xf bank_mask:0xf
  s_nop 1
  v_add_f32_dpp v21, v14, v21 quad_perm:[2,2,2,2] row_mask:0xf bank_mask:0xf
  s_nop 1
  v_add_f32_dpp v21, v15, v21 quad_perm:[3,3,3,3] row_mask:0xf bank_mask:0xf
  v_cndmask_b32 v20, v20, v21, s[30:31]
  s_waitcnt vmcnt(4)
  buffer_load_dwordx4 v[156:159], v1, s[24:27], s55 offen offset:1024 nt
  v_mfma_f32_16x16x32_bf16 v[12:15], v[160:163], v[8:11], 0
  v_mov_b32_dpp v21, v16 quad_perm:[0,0,0,0] row_mask:0xf bank_mask:0xf
  s_lshl_b64 s[30:31], s[30:31], 1
  s_nop 0
  v_add_f32_dpp v21, v17, v21 quad_perm:[1,1,1,1] row_mask:0xf bank_mask:0xf
  s_nop 1
  v_add_f32_dpp v21, v18, v21 quad_perm:[2,2,2,2] row_mask:0xf bank_mask:0xf
  s_nop 1
  v_add_f32_dpp v21, v19, v21 quad_perm:[3,3,3,3] row_mask:0xf bank_mask:0xf
  v_cndmask_b32 v20, v20, v21, s[30:31]
  s_waitcnt vmcnt(4)
  buffer_load_dwordx4 v[160:163], v1, s[24:27], s55 offen offset:2048 nt
  v_mfma_f32_16x16x32_bf16 v[16:19], v[164:167], v[8:11], 0
  v_mov_b32_dpp v21, v12 quad_perm:[0,0,0,0] row_mask:0xf bank_mask:0xf
  s_lshl_b64 s[30:31], s[30:31], 1
  s_nop 0
  v_add_f32_dpp v21, v13, v21 quad_perm:[1,1,1,1] row_mask:0xf bank_mask:0xf
  s_nop 1
  v_add_f32_dpp v21, v14, v21 quad_perm:[2,2,2,2] row_mask:0xf bank_mask:0xf
  s_nop 1
  v_add_f32_dpp v21, v15, v21 quad_perm:[3,3,3,3] row_mask:0xf bank_mask:0xf
  v_cndmask_b32 v20, v20, v21, s[30:31]
  s_waitcnt vmcnt(4)
  buffer_load_dwordx4 v[164:167], v1, s[24:27], s55 offen offset:3072 nt
  v_mov_b32_dpp v21, v16 quad_perm:[0,0,0,0] row_mask:0xf bank_mask:0xf
  s_lshl_b64 s[30:31], s[30:31], 1
  s_nop 0
  v_add_f32_dpp v21, v17, v21 quad_perm:[1,1,1,1] row_mask:0xf bank_mask:0xf
  s_nop 1
  v_add_f32_dpp v21, v18, v21 quad_perm:[2,2,2,2] row_mask:0xf bank_mask:0xf
  s_nop 1
  v_add_f32_dpp v21, v19, v21 quad_perm:[3,3,3,3] row_mask:0xf bank_mask:0xf
  v_cndmask_b32 v20, v20, v21, s[30:31]
  v_max_f32 v3, v3, v20
  ds_write_b32 v26, v20 offset:8960
  v_add_u32 v26, 1024, v26
  s_add_u32 s41, s41, 1
  s_cmp_lt_u32 s41, 8
  s_cbranch_scc1 L_kloop
  s_lshl_b32 s56, s3, 13
  s_add_u32 s56, s56, 8192
  v_and_b32 v6, 3, v0
  v_lshl_add_u32 v26, v6, 3, s56
  v_lshrrev_b32 v6, 5, v0
  v_lshl_add_u32 v26, v6, 2, v26
  v_bfe_u32 v6, v0, 3, 1
  v_lshl_add_u32 v26, v6, 5, v26
  v_bfe_u32 v6, v0, 4, 1
  v_lshl_add_u32 v26, v6, 7, v26
  s_waitcnt lgkmcnt(0)
  ds_read2_b32 v[22:23], v26 offset0:0 offset1:16
  s_nop 1
  v_max_f32_dpp v3, v3, v3 quad_perm:[1,0,3,2] row_mask:0xf bank_mask:0xf
  s_nop 1
  v_max_f32_dpp v3, v3, v3 quad_perm:[2,3,0,1] row_mask:0xf bank_mask:0xf
  s_nop 1
  v_max_f32_dpp v3, v3, v3 row_half_mirror row_mask:0xf bank_mask:0xf
  v_mov_b32 v7, v3
  s_nop 1
  v_permlane16_swap_b32 v3, v7
  s_nop 1
  v_max_f32 v3, v3, v7
  v_mov_b32 v7, v3
  s_nop 1
  v_permlane32_swap_b32 v3, v7
  s_nop 1
  v_max_f32 v3, v3, v7
  v_mul_f32 v5, s40, v3
  v_and_b32 v3, 8, v0
  s_mov_b32 s22, 32
L_vloop:
  s_or_b32 s59, s59, 0xfff1ffff
  s_add_u32 s59, s59, 1
  s_and_b32 s59, s59, 0xe0000
  s_add_u32 s36, s59, s58
  s_add_u32 s37, s36, 4096
  s_add_u32 s38, s36, 16384
  s_add_u32 s39, s36, 20480
  s_add_u32 s52, s36, 65536
  s_add_u32 s53, s36, 69632
  s_add_u32 s54, s36, 81920
  s_add_u32 s55, s36, 86016
  s_cmp_eq_u32 s41, 14
  s_cbranch_scc0 L_nonrm
L_nrm:
  ds_read_b64 v[6:7], v3 offset:560
  s_waitcnt lgkmcnt(0)
  v_cmp_eq_u32 vcc, 0, v7
  s_cbranch_vccnz L_nrm
  v_sub_f32 v7, v5, v6
  v_exp_f32 v7, v7
  v_mov_b32 v5, v6
  v_readlane_b32 s30, v7, 0
  v_readlane_b32 s31, v7, 8
  s_mov_b32 exec_hi, 0
  v_mul_f32 v28, s30, v28
  v_mul_f32 v29, s30, v29
  v_mul_f32 v30, s30, v30
  v_mul_f32 v31, s30, v31
  s_not_b64 exec, exec
  v_mul_f32 v28, s31, v28
  v_mul_f32 v29, s31, v29
  v_mul_f32 v30, s31, v30
  v_mul_f32 v31, s31, v31
  s_mov_b64 exec, -1
L_nonrm:
  s_waitcnt lgkmcnt(0)
  v_fma_f32 v6, v22, s40, -v5
  v_fma_f32 v7, v23, s40, -v5
  v_readfirstlane_b32 s42, v27
  v_exp_f32 v6, v6
  v_exp_f32 v7, v7
  v_mov_b32 v37, s22
  v_cvt_pk_bf16_f32 v24, v6, v7
  ds_read2_b32 v[22:23], v26 offset0:64 offset1:80
  ds_read_b32 v27, v36 offset:528
  v_and_b32_dpp v12, v24, v32 quad_perm:[0,0,0,0] row_mask:0xf bank_mask:0xf
  v_and_b32_dpp v13, v24, v33 quad_perm:[0,0,0,0] row_mask:0xf bank_mask:0xf
  v_and_b32_dpp v14, v24, v34 quad_perm:[0,0,0,0] row_mask:0xf bank_mask:0xf
  v_and_b32_dpp v15, v24, v35 quad_perm:[0,0,0,0] row_mask:0xf bank_mask:0xf
  ds_write_b32 v36, v37 offset:544
  s_cmp_ge_u32 s22, 56
  s_cselect_b32 s42, 64, s42
  s_cmp_lt_u32 s22, s42
  s_cselect_b64 vcc, -1, 0
  s_add_u32 s22, s22, 1
  v_smfmac_f32_16x16x64_bf16 v[28:31], v[12:15], v[40:47], v25
  v_and_b32_dpp v16, v24, v32 quad_perm:[1,1,1,1] row_mask:0xf bank_mask:0xf
  v_and_b32_dpp v17, v24, v33 quad_perm:[1,1,1,1] row_mask:0xf bank_mask:0xf
  v_and_b32_dpp v18, v24, v34 quad_perm:[1,1,1,1] row_mask:0xf bank_mask:0xf
  v_and_b32_dpp v19, v24, v35 quad_perm:[1,1,1,1] row_mask:0xf bank_mask:0xf
  s_cbranch_vccnz L_vb0
  s_waitcnt vmcnt(4)
L_vb0:
  s_waitcnt vmcnt(11)
  buffer_load_dwordx4 v[40:43], v1, s[24:27], s36 offen offset:0 nt
  s_cbranch_vccnz L_vb1
  s_waitcnt vmcnt(4)
L_vb1:
  s_waitcnt vmcnt(11)
  buffer_load_dwordx4 v[44:47], v1, s[24:27], s36 offen offset:1024 nt
  v_smfmac_f32_16x16x64_bf16 v[28:31], v[16:19], v[48:55], v25
  v_and_b32_dpp v12, v24, v32 quad_perm:[2,2,2,2] row_mask:0xf bank_mask:0xf
  v_and_b32_dpp v13, v24, v33 quad_perm:[2,2,2,2] row_mask:0xf bank_mask:0xf
  v_and_b32_dpp v14, v24, v34 quad_perm:[2,2,2,2] row_mask:0xf bank_mask:0xf
  v_and_b32_dpp v15, v24, v35 quad_perm:[2,2,2,2] row_mask:0xf bank_mask:0xf
  s_cbranch_vccnz L_vb2
  s_waitcnt vmcnt(4)
L_vb2:
  s_waitcnt vmcnt(11)
  buffer_load_dwordx4 v[48:51], v1, s[24:27], s36 offen offset:2048 nt
  s_cbranch_vccnz L_vb3
  s_waitcnt vmcnt(4)
L_vb3:
  s_waitcnt vmcnt(11)
  buffer_load_dwordx4 v[52:55], v1, s[24:27], s36 offen offset:3072 nt
  v_smfmac_f32_16x16x64_bf16 v[28:31], v[12:15], v[56:63], v25
  v_and_b32_dpp v16, v24, v32 quad_perm:[3,3,3,3] row_mask:0xf bank_mask:0xf
  v_and_b32_dpp v17, v24, v33 quad_perm:[3,3,3,3] row_mask:0xf bank_mask:0xf
  v_and_b32_dpp v18, v24, v34 quad_perm:[3,3,3,3] row_mask:0xf bank_mask:0xf
  v_and_b32_dpp v19, v24, v35 quad_perm:[3,3,3,3] row_mask:0xf bank_mask:0xf
  s_cbranch_vccnz L_vb4
  s_waitcnt vmcnt(4)
L_vb4:
  s_waitcnt vmcnt(11)
  buffer_load_dwordx4 v[56:59], v1, s[24:27], s37 offen offset:0 nt
  s_cbranch_vccnz L_vb5
  s_waitcnt vmcnt(4)
L_vb5:
  s_waitcnt vmcnt(11)
  buffer_load_dwordx4 v[60:63], v1, s[24:27], s37 offen offset:1024 nt
  v_smfmac_f32_16x16x64_bf16 v[28:31], v[16:19], v[64:71], v25
  s_cbranch_vccnz L_vb6
  s_waitcnt vmcnt(4)
L_vb6:
  s_waitcnt vmcnt(11)
  buffer_load_dwordx4 v[64:67], v1, s[24:27], s37 offen offset:2048 nt
  s_cbranch_vccnz L_vb7
  s_waitcnt vmcnt(4)
L_vb7:
  s_waitcnt vmcnt(11)
  buffer_load_dwordx4 v[68:71], v1, s[24:27], s37 offen offset:3072 nt
  s_waitcnt lgkmcnt(0)
  v_fma_f32 v6, v22, s40, -v5
  v_fma_f32 v7, v23, s40, -v5
  v_readfirstlane_b32 s42, v27
  v_exp_f32 v6, v6
  v_exp_f32 v7, v7
  v_mov_b32 v37, s22
  v_cvt_pk_bf16_f32 v24, v6, v7
  ds_read2_b32 v[22:23], v26 offset0:128 offset1:144
  ds_read_b32 v27, v36 offset:528
  v_and_b32_dpp v12, v24, v32 quad_perm:[0,0,0,0] row_mask:0xf bank_mask:0xf
  v_and_b32_dpp v13, v24, v33 quad_perm:[0,0,0,0] row_mask:0xf bank_mask:0xf
  v_and_b32_dpp v14, v24, v34 quad_perm:[0,0,0,0] row_mask:0xf bank_mask:0xf
  v_and_b32_dpp v15, v24, v35 quad_perm:[0,0,0,0] row_mask:0xf bank_mask:0xf
  ds_write_b32 v36, v37 offset:544
  s_cmp_ge_u32 s22, 56
  s_cselect_b32 s42, 64, s42
  s_cmp_lt_u32 s22, s42
  s_cselect_b64 vcc, -1, 0
  s_add_u32 s22, s22, 1
  v_smfmac_f32_16x16x64_bf16 v[28:31], v[12:15], v[72:79], v25
  v_and_b32_dpp v16, v24, v32 quad_perm:[1,1,1,1] row_mask:0xf bank_mask:0xf
  v_and_b32_dpp v17, v24, v33 quad_perm:[1,1,1,1] row_mask:0xf bank_mask:0xf
  v_and_b32_dpp v18, v24, v34 quad_perm:[1,1,1,1] row_mask:0xf bank_mask:0xf
  v_and_b32_dpp v19, v24, v35 quad_perm:[1,1,1,1] row_mask:0xf bank_mask:0xf
  s_cbranch_vccnz L_vb8
  s_waitcnt vmcnt(4)
L_vb8:
  s_waitcnt vmcnt(11)
  buffer_load_dwordx4 v[72:75], v1, s[24:27], s38 offen offset:0 nt
  s_cbranch_vccnz L_vb9
  s_waitcnt vmcnt(4)
L_vb9:
  s_waitcnt vmcnt(11)
  buffer_load_dwordx4 v[76:79], v1, s[24:27], s38 offen offset:1024 nt
  v_smfmac_f32_16x16x64_bf16 v[28:31], v[16:19], v[80:87], v25
  v_and_b32_dpp v12, v24, v32 quad_perm:[2,2,2,2] row_mask:0xf bank_mask:0xf
  v_and_b32_dpp v13, v24, v33 quad_perm:[2,2,2,2] row_mask:0xf bank_mask:0xf
  v_and_b32_dpp v14, v24, v34 quad_perm:[2,2,2,2] row_mask:0xf bank_mask:0xf
  v_and_b32_dpp v15, v24, v35 quad_perm:[2,2,2,2] row_mask:0xf bank_mask:0xf
  s_cbranch_vccnz L_vb10
  s_waitcnt vmcnt(4)
L_vb10:
  s_waitcnt vmcnt(11)
  buffer_load_dwordx4 v[80:83], v1, s[24:27], s38 offen offset:2048 nt
  s_cbranch_vccnz L_vb11
  s_waitcnt vmcnt(4)
L_vb11:
  s_waitcnt vmcnt(11)
  buffer_load_dwordx4 v[84:87], v1, s[24:27], s38 offen offset:3072 nt
  v_smfmac_f32_16x16x64_bf16 v[28:31], v[12:15], v[88:95], v25
  v_and_b32_dpp v16, v24, v32 quad_perm:[3,3,3,3] row_mask:0xf bank_mask:0xf
  v_and_b32_dpp v17, v24, v33 quad_perm:[3,3,3,3] row_mask:0xf bank_mask:0xf
  v_and_b32_dpp v18, v24, v34 quad_perm:[3,3,3,3] row_mask:0xf bank_mask:0xf
  v_and_b32_dpp v19, v24, v35 quad_perm:[3,3,3,3] row_mask:0xf bank_mask:0xf
  s_cbranch_vccnz L_vb12
  s_waitcnt vmcnt(4)
L_vb12:
  s_waitcnt vmcnt(11)
  buffer_load_dwordx4 v[88:91], v1, s[24:27], s39 offen offset:0 nt
  s_cbranch_vccnz L_vb13
  s_waitcnt vmcnt(4)
L_vb13:
  s_waitcnt vmcnt(11)
  buffer_load_dwordx4 v[92:95], v1, s[24:27], s39 offen offset:1024 nt
  v_smfmac_f32_16x16x64_bf16 v[28:31], v[16:19], v[96:103], v25
  s_cbranch_vccnz L_vb14
  s_waitcnt vmcnt(4)
L_vb14:
  s_waitcnt vmcnt(11)
  buffer_load_dwordx4 v[96:99], v1, s[24:27], s39 offen offset:2048 nt
  s_cbranch_vccnz L_vb15
  s_waitcnt vmcnt(4)
L_vb15:
  s_waitcnt vmcnt(11)
  buffer_load_dwordx4 v[100:103], v1, s[24:27], s39 offen offset:3072 nt
  s_waitcnt lgkmcnt(0)
  v_fma_f32 v6, v22, s40, -v5
  v_fma_f32 v7, v23, s40, -v5
  v_readfirstlane_b32 s42, v27
  v_exp_f32 v6, v6
  v_exp_f32 v7, v7
  v_mov_b32 v37, s22
  v_cvt_pk_bf16_f32 v24, v6, v7
  ds_read2_b32 v[22:23], v26 offset0:192 offset1:208
  ds_read_b32 v27, v36 offset:528
  v_and_b32_dpp v12, v24, v32 quad_perm:[0,0,0,0] row_mask:0xf bank_mask:0xf
  v_and_b32_dpp v13, v24, v33 quad_perm:[0,0,0,0] row_mask:0xf bank_mask:0xf
  v_and_b32_dpp v14, v24, v34 quad_perm:[0,0,0,0] row_mask:0xf bank_mask:0xf
  v_and_b32_dpp v15, v24, v35 quad_perm:[0,0,0,0] row_mask:0xf bank_mask:0xf
  ds_write_b32 v36, v37 offset:544
  s_cmp_ge_u32 s22, 56
  s_cselect_b32 s42, 64, s42
  s_cmp_lt_u32 s22, s42
  s_cselect_b64 vcc, -1, 0
  s_add_u32 s22, s22, 1
  v_smfmac_f32_16x16x64_bf16 v[28:31], v[12:15], v[104:111], v25
  v_and_b32_dpp v16, v24, v32 quad_perm:[1,1,1,1] row_mask:0xf bank_mask:0xf
  v_and_b32_dpp v17, v24, v33 quad_perm:[1,1,1,1] row_mask:0xf bank_mask:0xf
  v_and_b32_dpp v18, v24, v34 quad_perm:[1,1,1,1] row_mask:0xf bank_mask:0xf
  v_and_b32_dpp v19, v24, v35 quad_perm:[1,1,1,1] row_mask:0xf bank_mask:0xf
  s_cbranch_vccnz L_vb16
  s_waitcnt vmcnt(4)
L_vb16:
  s_waitcnt vmcnt(11)
  buffer_load_dwordx4 v[104:107], v1, s[24:27], s52 offen offset:0 nt
  s_cbranch_vccnz L_vb17
  s_waitcnt vmcnt(4)
L_vb17:
  s_waitcnt vmcnt(11)
  buffer_load_dwordx4 v[108:111], v1, s[24:27], s52 offen offset:1024 nt
  v_smfmac_f32_16x16x64_bf16 v[28:31], v[16:19], v[112:119], v25
  v_and_b32_dpp v12, v24, v32 quad_perm:[2,2,2,2] row_mask:0xf bank_mask:0xf
  v_and_b32_dpp v13, v24, v33 quad_perm:[2,2,2,2] row_mask:0xf bank_mask:0xf
  v_and_b32_dpp v14, v24, v34 quad_perm:[2,2,2,2] row_mask:0xf bank_mask:0xf
  v_and_b32_dpp v15, v24, v35 quad_perm:[2,2,2,2] row_mask:0xf bank_mask:0xf
  s_cbranch_vccnz L_vb18
  s_waitcnt vmcnt(4)
L_vb18:
  s_waitcnt vmcnt(11)
  buffer_load_dwordx4 v[112:115], v1, s[24:27], s52 offen offset:2048 nt
  s_cbranch_vccnz L_vb19
  s_waitcnt vmcnt(4)
L_vb19:
  s_waitcnt vmcnt(11)
  buffer_load_dwordx4 v[116:119], v1, s[24:27], s52 offen offset:3072 nt
  v_smfmac_f32_16x16x64_bf16 v[28:31], v[12:15], v[120:127], v25
  v_and_b32_dpp v16, v24, v32 quad_perm:[3,3,3,3] row_mask:0xf bank_mask:0xf
  v_and_b32_dpp v17, v24, v33 quad_perm:[3,3,3,3] row_mask:0xf bank_mask:0xf
  v_and_b32_dpp v18, v24, v34 quad_perm:[3,3,3,3] row_mask:0xf bank_mask:0xf
  v_and_b32_dpp v19, v24, v35 quad_perm:[3,3,3,3] row_mask:0xf bank_mask:0xf
  s_cbranch_vccnz L_vb20
  s_waitcnt vmcnt(4)
L_vb20:
  s_waitcnt vmcnt(11)
  buffer_load_dwordx4 v[120:123], v1, s[24:27], s53 offen offset:0 nt
  s_cbranch_vccnz L_vb21
  s_waitcnt vmcnt(4)
L_vb21:
  s_waitcnt vmcnt(11)
  buffer_load_dwordx4 v[124:127], v1, s[24:27], s53 offen offset:1024 nt
  v_smfmac_f32_16x16x64_bf16 v[28:31], v[16:19], v[128:135], v25
  s_cbranch_vccnz L_vb22
  s_waitcnt vmcnt(4)
L_vb22:
  s_waitcnt vmcnt(11)
  buffer_load_dwordx4 v[128:131], v1, s[24:27], s53 offen offset:2048 nt
  s_cbranch_vccnz L_vb23
  s_waitcnt vmcnt(4)
L_vb23:
  s_waitcnt vmcnt(11)
  buffer_load_dwordx4 v[132:135], v1, s[24:27], s53 offen offset:3072 nt
  s_waitcnt lgkmcnt(0)
  v_fma_f32 v6, v22, s40, -v5
  v_fma_f32 v7, v23, s40, -v5
  v_add_u32 v26, 1024, v26
  v_readfirstlane_b32 s42, v27
  v_exp_f32 v6, v6
  v_exp_f32 v7, v7
  v_mov_b32 v37, s22
  v_cvt_pk_bf16_f32 v24, v6, v7
  ds_read2_b32 v[22:23], v26 offset0:0 offset1:16
  ds_read_b32 v27, v36 offset:528
  v_and_b32_dpp v12, v24, v32 quad_perm:[0,0,0,0] row_mask:0xf bank_mask:0xf
  v_and_b32_dpp v13, v24, v33 quad_perm:[0,0,0,0] row_mask:0xf bank_mask:0xf
  v_and_b32_dpp v14, v24, v34 quad_perm:[0,0,0,0] row_mask:0xf bank_mask:0xf
  v_and_b32_dpp v15, v24, v35 quad_perm:[0,0,0,0] row_mask:0xf bank_mask:0xf
  ds_write_b32 v36, v37 offset:544
  s_cmp_ge_u32 s22, 56
  s_cselect_b32 s42, 64, s42
  s_cmp_lt_u32 s22, s42
  s_cselect_b64 vcc, -1, 0
  s_add_u32 s22, s22, 1
  v_smfmac_f32_16x16x64_bf16 v[28:31], v[12:15], v[136:143], v25
  v_and_b32_dpp v16, v24, v32 quad_perm:[1,1,1,1] row_mask:0xf bank_mask:0xf
  v_and_b32_dpp v17, v24, v33 quad_perm:[1,1,1,1] row_mask:0xf bank_mask:0xf
  v_and_b32_dpp v18, v24, v34 quad_perm:[1,1,1,1] row_mask:0xf bank_mask:0xf
  v_and_b32_dpp v19, v24, v35 quad_perm:[1,1,1,1] row_mask:0xf bank_mask:0xf
  s_cbranch_vccnz L_vb24
  s_waitcnt vmcnt(4)
L_vb24:
  s_waitcnt vmcnt(11)
  buffer_load_dwordx4 v[136:139], v1, s[24:27], s54 offen offset:0 nt
  s_cbranch_vccnz L_vb25
  s_waitcnt vmcnt(4)
L_vb25:
  s_waitcnt vmcnt(11)
  buffer_load_dwordx4 v[140:143], v1, s[24:27], s54 offen offset:1024 nt
  v_smfmac_f32_16x16x64_bf16 v[28:31], v[16:19], v[144:151], v25
  v_and_b32_dpp v12, v24, v32 quad_perm:[2,2,2,2] row_mask:0xf bank_mask:0xf
  v_and_b32_dpp v13, v24, v33 quad_perm:[2,2,2,2] row_mask:0xf bank_mask:0xf
  v_and_b32_dpp v14, v24, v34 quad_perm:[2,2,2,2] row_mask:0xf bank_mask:0xf
  v_and_b32_dpp v15, v24, v35 quad_perm:[2,2,2,2] row_mask:0xf bank_mask:0xf
  s_cbranch_vccnz L_vb26
  s_waitcnt vmcnt(4)
L_vb26:
  s_waitcnt vmcnt(11)
  buffer_load_dwordx4 v[144:147], v1, s[24:27], s54 offen offset:2048 nt
  s_cbranch_vccnz L_vb27
  s_waitcnt vmcnt(4)
L_vb27:
  s_waitcnt vmcnt(11)
  buffer_load_dwordx4 v[148:151], v1, s[24:27], s54 offen offset:3072 nt
  v_smfmac_f32_16x16x64_bf16 v[28:31], v[12:15], v[152:159], v25
  v_and_b32_dpp v16, v24, v32 quad_perm:[3,3,3,3] row_mask:0xf bank_mask:0xf
  v_and_b32_dpp v17, v24, v33 quad_perm:[3,3,3,3] row_mask:0xf bank_mask:0xf
  v_and_b32_dpp v18, v24, v34 quad_perm:[3,3,3,3] row_mask:0xf bank_mask:0xf
  v_and_b32_dpp v19, v24, v35 quad_perm:[3,3,3,3] row_mask:0xf bank_mask:0xf
  s_cbranch_vccnz L_vb28
  s_waitcnt vmcnt(4)
L_vb28:
  s_waitcnt vmcnt(11)
  buffer_load_dwordx4 v[152:155], v1, s[24:27], s55 offen offset:0 nt
  s_cbranch_vccnz L_vb29
  s_waitcnt vmcnt(4)
L_vb29:
  s_waitcnt vmcnt(11)
  buffer_load_dwordx4 v[156:159], v1, s[24:27], s55 offen offset:1024 nt
  v_smfmac_f32_16x16x64_bf16 v[28:31], v[16:19], v[160:167], v25
  s_cbranch_vccnz L_vb30
  s_waitcnt vmcnt(4)
L_vb30:
  s_waitcnt vmcnt(11)
  buffer_load_dwordx4 v[160:163], v1, s[24:27], s55 offen offset:2048 nt
  s_cbranch_vccnz L_vb31
  s_waitcnt vmcnt(4)
L_vb31:
  s_waitcnt vmcnt(11)
  buffer_load_dwordx4 v[164:167], v1, s[24:27], s55 offen offset:3072 nt
  s_add_u32 s41, s41, 1
  s_cmp_lt_u32 s41, 15
  s_cbranch_scc1 L_vloop
  ds_read2_b32 v[8:9], v26 offset0:64 offset1:80
  ds_read2_b32 v[10:11], v26 offset0:128 offset1:144
  ds_read2_b32 v[20:21], v26 offset0:192 offset1:208
  v_mov_b32 v1, s43
  v_mov_b32 v38, 1
  s_mov_b64 exec, 1
  buffer_atomic_add v38, v1, s[32:35], 0 offen sc0
  s_mov_b64 exec, -1
  s_waitcnt lgkmcnt(3)
  v_fma_f32 v22, v22, s40, -v5
  v_fma_f32 v23, v23, s40, -v5
  v_exp_f32 v22, v22
  v_exp_f32 v23, v23
  s_nop 0
  v_cvt_pk_bf16_f32 v22, v22, v23
  s_lshl_b32 s52, s3, 14
  s_sub_u32 s52, s52, 16384
  v_and_b32_dpp v12, v22, v32 quad_perm:[0,0,0,0] row_mask:0xf bank_mask:0xf
  v_and_b32_dpp v13, v22, v33 quad_perm:[0,0,0,0] row_mask:0xf bank_mask:0xf
  v_and_b32_dpp v14, v22, v34 quad_perm:[0,0,0,0] row_mask:0xf bank_mask:0xf
  v_and_b32_dpp v15, v22, v35 quad_perm:[0,0,0,0] row_mask:0xf bank_mask:0xf
  s_waitcnt lgkmcnt(0)
  s_nop 0
  v_smfmac_f32_16x16x64_bf16 v[28:31], v[12:15], v[40:47], v25
  v_and_b32_dpp v16, v22, v32 quad_perm:[1,1,1,1] row_mask:0xf bank_mask:0xf
  v_and_b32_dpp v17, v22, v33 quad_perm:[1,1,1,1] row_mask:0xf bank_mask:0xf
  v_and_b32_dpp v18, v22, v34 quad_perm:[1,1,1,1] row_mask:0xf bank_mask:0xf
  v_and_b32_dpp v19, v22, v35 quad_perm:[1,1,1,1] row_mask:0xf bank_mask:0xf
  s_nop 0
  s_nop 0
  v_smfmac_f32_16x16x64_bf16 v[28:31], v[16:19], v[48:55], v25
  v_fma_f32 v8, v8, s40, -v5
  v_fma_f32 v9, v9, s40, -v5
  v_exp_f32 v8, v8
  v_exp_f32 v9, v9
  s_nop 0
  v_cvt_pk_bf16_f32 v8, v8, v9
  v_and_b32_dpp v12, v22, v32 quad_perm:[2,2,2,2] row_mask:0xf bank_mask:0xf
  v_and_b32_dpp v13, v22, v33 quad_perm:[2,2,2,2] row_mask:0xf bank_mask:0xf
  v_and_b32_dpp v14, v22, v34 quad_perm:[2,2,2,2] row_mask:0xf bank_mask:0xf
  v_and_b32_dpp v15, v22, v35 quad_perm:[2,2,2,2] row_mask:0xf bank_mask:0xf
  s_nop 0
  s_nop 0
  v_smfmac_f32_16x16x64_bf16 v[28:31], v[12:15], v[56:63], v25
  v_and_b32_dpp v16, v22, v32 quad_perm:[3,3,3,3] row_mask:0xf bank_mask:0xf
  v_and_b32_dpp v17, v22, v33 quad_perm:[3,3,3,3] row_mask:0xf bank_mask:0xf
  v_and_b32_dpp v18, v22, v34 quad_perm:[3,3,3,3] row_mask:0xf bank_mask:0xf
  v_and_b32_dpp v19, v22, v35 quad_perm:[3,3,3,3] row_mask:0xf bank_mask:0xf
  s_nop 0
  s_nop 0
  v_smfmac_f32_16x16x64_bf16 v[28:31], v[16:19], v[64:71], v25
  v_and_b32_dpp v12, v8, v32 quad_perm:[0,0,0,0] row_mask:0xf bank_mask:0xf
  v_and_b32_dpp v13, v8, v33 quad_perm:[0,0,0,0] row_mask:0xf bank_mask:0xf
  v_and_b32_dpp v14, v8, v34 quad_perm:[0,0,0,0] row_mask:0xf bank_mask:0xf
  v_and_b32_dpp v15, v8, v35 quad_perm:[0,0,0,0] row_mask:0xf bank_mask:0xf
  s_nop 0
  s_nop 0
  v_smfmac_f32_16x16x64_bf16 v[28:31], v[12:15], v[72:79], v25
  v_and_b32_dpp v16, v8, v32 quad_perm:[1,1,1,1] row_mask:0xf bank_mask:0xf
  v_and_b32_dpp v17, v8, v33 quad_perm:[1,1,1,1] row_mask:0xf bank_mask:0xf
  v_and_b32_dpp v18, v8, v34 quad_perm:[1,1,1,1] row_mask:0xf bank_mask:0xf
  v_and_b32_dpp v19, v8, v35 quad_perm:[1,1,1,1] row_mask:0xf bank_mask:0xf
  s_nop 0
  s_nop 0
  v_smfmac_f32_16x16x64_bf16 v[28:31], v[16:19], v[80:87], v25
  v_fma_f32 v10, v10, s40, -v5
  v_fma_f32 v11, v11, s40, -v5
  v_exp_f32 v10, v10
  v_exp_f32 v11, v11
  s_nop 0
  v_cvt_pk_bf16_f32 v10, v10, v11
  v_and_b32_dpp v12, v8, v32 quad_perm:[2,2,2,2] row_mask:0xf bank_mask:0xf
  v_and_b32_dpp v13, v8, v33 quad_perm:[2,2,2,2] row_mask:0xf bank_mask:0xf
  v_and_b32_dpp v14, v8, v34 quad_perm:[2,2,2,2] row_mask:0xf bank_mask:0xf
  v_and_b32_dpp v15, v8, v35 quad_perm:[2,2,2,2] row_mask:0xf bank_mask:0xf
  s_nop 0
  s_nop 0
  v_smfmac_f32_16x16x64_bf16 v[28:31], v[12:15], v[88:95], v25
  v_and_b32_dpp v16, v8, v32 quad_perm:[3,3,3,3] row_mask:0xf bank_mask:0xf
  v_and_b32_dpp v17, v8, v33 quad_perm:[3,3,3,3] row_mask:0xf bank_mask:0xf
  v_and_b32_dpp v18, v8, v34 quad_perm:[3,3,3,3] row_mask:0xf bank_mask:0xf
  v_and_b32_dpp v19, v8, v35 quad_perm:[3,3,3,3] row_mask:0xf bank_mask:0xf
  s_nop 0
  s_nop 0
  v_smfmac_f32_16x16x64_bf16 v[28:31], v[16:19], v[96:103], v25
  v_and_b32_dpp v12, v10, v32 quad_perm:[0,0,0,0] row_mask:0xf bank_mask:0xf
  v_and_b32_dpp v13, v10, v33 quad_perm:[0,0,0,0] row_mask:0xf bank_mask:0xf
  v_and_b32_dpp v14, v10, v34 quad_perm:[0,0,0,0] row_mask:0xf bank_mask:0xf
  v_and_b32_dpp v15, v10, v35 quad_perm:[0,0,0,0] row_mask:0xf bank_mask:0xf
  s_nop 0
  s_nop 0
  v_smfmac_f32_16x16x64_bf16 v[28:31], v[12:15], v[104:111], v25
  v_and_b32_dpp v16, v10, v32 quad_perm:[1,1,1,1] row_mask:0xf bank_mask:0xf
  v_and_b32_dpp v17, v10, v33 quad_perm:[1,1,1,1] row_mask:0xf bank_mask:0xf
  v_and_b32_dpp v18, v10, v34 quad_perm:[1,1,1,1] row_mask:0xf bank_mask:0xf
  v_and_b32_dpp v19, v10, v35 quad_perm:[1,1,1,1] row_mask:0xf bank_mask:0xf
  s_nop 0
  s_nop 0
  v_smfmac_f32_16x16x64_bf16 v[28:31], v[16:19], v[112:119], v25
  v_fma_f32 v20, v20, s40, -v5
  v_fma_f32 v21, v21, s40, -v5
  v_exp_f32 v20, v20
  v_exp_f32 v21, v21
  s_nop 0
  v_cvt_pk_bf16_f32 v20, v20, v21
  v_and_b32_dpp v12, v10, v32 quad_perm:[2,2,2,2] row_mask:0xf bank_mask:0xf
  v_and_b32_dpp v13, v10, v33 quad_perm:[2,2,2,2] row_mask:0xf bank_mask:0xf
  v_and_b32_dpp v14, v10, v34 quad_perm:[2,2,2,2] row_mask:0xf bank_mask:0xf
  v_and_b32_dpp v15, v10, v35 quad_perm:[2,2,2,2] row_mask:0xf bank_mask:0xf
  s_nop 0
  s_waitcnt vmcnt(11)
  v_smfmac_f32_16x16x64_bf16 v[28:31], v[12:15], v[120:127], v25
  v_and_b32_dpp v16, v10, v32 quad_perm:[3,3,3,3] row_mask:0xf bank_mask:0xf
  v_and_b32_dpp v17, v10, v33 quad_perm:[3,3,3,3] row_mask:0xf bank_mask:0xf
  v_and_b32_dpp v18, v10, v34 quad_perm:[3,3,3,3] row_mask:0xf bank_mask:0xf
  v_and_b32_dpp v19, v10, v35 quad_perm:[3,3,3,3] row_mask:0xf bank_mask:0xf
  s_nop 0
  s_waitcnt vmcnt(9)
  v_smfmac_f32_16x16x64_bf16 v[28:31], v[16:19], v[128:135], v25
  v_and_b32_dpp v12, v20, v32 quad_perm:[0,0,0,0] row_mask:0xf bank_mask:0xf
  v_and_b32_dpp v13, v20, v33 quad_perm:[0,0,0,0] row_mask:0xf bank_mask:0xf
  v_and_b32_dpp v14, v20, v34 quad_perm:[0,0,0,0] row_mask:0xf bank_mask:0xf
  v_and_b32_dpp v15, v20, v35 quad_perm:[0,0,0,0] row_mask:0xf bank_mask:0xf
  s_nop 0
  s_waitcnt vmcnt(7)
  v_smfmac_f32_16x16x64_bf16 v[28:31], v[12:15], v[136:143], v25
  v_and_b32_dpp v16, v20, v32 quad_perm:[1,1,1,1] row_mask:0xf bank_mask:0xf
  v_and_b32_dpp v17, v20, v33 quad_perm:[1,1,1,1] row_mask:0xf bank_mask:0xf
  v_and_b32_dpp v18, v20, v34 quad_perm:[1,1,1,1] row_mask:0xf bank_mask:0xf
  v_and_b32_dpp v19, v20, v35 quad_perm:[1,1,1,1] row_mask:0xf bank_mask:0xf
  s_nop 0
  s_waitcnt vmcnt(5)
  v_smfmac_f32_16x16x64_bf16 v[28:31], v[16:19], v[144:151], v25
  v_and_b32_dpp v12, v20, v32 quad_perm:[2,2,2,2] row_mask:0xf bank_mask:0xf
  v_and_b32_dpp v13, v20, v33 quad_perm:[2,2,2,2] row_mask:0xf bank_mask:0xf
  v_and_b32_dpp v14, v20, v34 quad_perm:[2,2,2,2] row_mask:0xf bank_mask:0xf
  v_and_b32_dpp v15, v20, v35 quad_perm:[2,2,2,2] row_mask:0xf bank_mask:0xf
  s_nop 0
  s_waitcnt vmcnt(3)
  v_smfmac_f32_16x16x64_bf16 v[28:31], v[12:15], v[152:159], v25
  v_and_b32_dpp v16, v20, v32 quad_perm:[3,3,3,3] row_mask:0xf bank_mask:0xf
  v_and_b32_dpp v17, v20, v33 quad_perm:[3,3,3,3] row_mask:0xf bank_mask:0xf
  v_and_b32_dpp v18, v20, v34 quad_perm:[3,3,3,3] row_mask:0xf bank_mask:0xf
  v_and_b32_dpp v19, v20, v35 quad_perm:[3,3,3,3] row_mask:0xf bank_mask:0xf
  s_nop 0
  s_waitcnt vmcnt(1)
  v_smfmac_f32_16x16x64_bf16 v[28:31], v[16:19], v[160:167], v25
  v_lshl_add_u32 v6, v0, 4, s52
  v_mov_b32 v1, 0
  s_nop 6
  ds_write_b128 v4, v[28:31]
  s_cmp_eq_u32 s3, 1
  s_cbranch_scc0 L_nt3
  s_waitcnt vmcnt(0)
  s_mov_b64 exec, 1
  ds_write_b32 v1, v38 offset:516
  s_mov_b64 exec, -1
L_nt3:
  s_waitcnt lgkmcnt(0)
  s_barrier
  ds_read_b32 v37, v1 offset:516
  s_waitcnt vmcnt(0) lgkmcnt(0)
  v_readfirstlane_b32 s53, v37
  s_cmp_lg_u32 s3, 0
  s_cbranch_scc1 L_final
  s_cmp_eq_u32 s53, 15
  s_cbranch_scc0 L_done
  s_lshl_b32 s43, s21, 7
  s_add_u32 s43, s43, 4184064
  v_mov_b32 v8, s43
  s_mov_b64 exec, 1
  global_store_dword v8, v39, s[18:19] sc1
  s_branch L_done
L_final:
  s_lshl_b32 s52, s53, 10
  s_cmp_eq_u32 s53, 15
  s_cbranch_scc0 L_f_b
  s_movk_i32 s36, 4096
  s_movk_i32 s37, 8192
  s_movk_i32 s38, 12288
  buffer_load_dwordx4 v[72:75], v6, s[44:47], 0 offen offset:0 sc1
  buffer_load_dwordx4 v[76:79], v6, s[44:47], 0 offen offset:1024 sc1
  buffer_load_dwordx4 v[80:83], v6, s[44:47], 0 offen offset:2048 sc1
  buffer_load_dwordx4 v[84:87], v6, s[44:47], 0 offen offset:3072 sc1
  buffer_load_dwordx4 v[88:91], v6, s[44:47], s36 offen offset:0 sc1
  buffer_load_dwordx4 v[92:95], v6, s[44:47], s36 offen offset:1024 sc1
  buffer_load_dwordx4 v[96:99], v6, s[44:47], s36 offen offset:2048 sc1
  buffer_load_dwordx4 v[100:103], v6, s[44:47], s36 offen offset:3072 sc1
L_f_b:
  s_lshl_b32 s54, s3, 6
  s_sub_u32 s54, s54, 64
  v_add_u32 v3, s54, v0
  v_lshlrev_b32 v8, 2, v3
  v_lshlrev_b32 v7, 1, v3
  v_mov_b32 v40, 0
  v_mov_b32 v41, 0
  v_mov_b32 v42, 0
  s_cmp_eq_u32 s53, 15
  s_cbranch_scc0 L_f_g
  s_mov_b32 s55, 1000000
  s_movk_i32 s57, 0x7fff
  s_waitcnt vmcnt(7)
  v_cmp_ne_u32 vcc, v75, v39
  s_cbranch_vccnz L_c0
  s_bitset0_b32 s57, 0
  v_add_f32 v40, v40, v72
  v_add_f32 v41, v41, v73
  v_add_f32 v42, v42, v74
L_c0:
  s_waitcnt vmcnt(6)
  v_cmp_ne_u32 vcc, v79, v39
  s_cbranch_vccnz L_c1
  s_bitset0_b32 s57, 1
  v_add_f32 v40, v40, v76
  v_add_f32 v41, v41, v77
  v_add_f32 v42, v42, v78
L_c1:
  s_waitcnt vmcnt(5)
  v_cmp_ne_u32 vcc, v83, v39
  s_cbranch_vccnz L_c2
  s_bitset0_b32 s57, 2
  v_add_f32 v40, v40, v80
  v_add_f32 v41, v41, v81
  v_add_f32 v42, v42, v82
L_c2:
  s_waitcnt vmcnt(4)
  v_cmp_ne_u32 vcc, v87, v39
  s_cbranch_vccnz L_c3
  s_bitset0_b32 s57, 3
  v_add_f32 v40, v40, v84
  v_add_f32 v41, v41, v85
  v_add_f32 v42, v42, v86
L_c3:
  s_waitcnt vmcnt(3)
  v_cmp_ne_u32 vcc, v91, v39
  s_cbranch_vccnz L_c4
  s_bitset0_b32 s57, 4
  v_add_f32 v40, v40, v88
  v_add_f32 v41, v41, v89
  v_add_f32 v42, v42, v90
L_c4:
  s_waitcnt vmcnt(2)
  v_cmp_ne_u32 vcc, v95, v39
  s_cbranch_vccnz L_c5
  s_bitset0_b32 s57, 5
  v_add_f32 v40, v40, v92
  v_add_f32 v41, v41, v93
  v_add_f32 v42, v42, v94
L_c5:
  s_waitcnt vmcnt(1)
  v_cmp_ne_u32 vcc, v99, v39
  s_cbranch_vccnz L_c6
  s_bitset0_b32 s57, 6
  v_add_f32 v40, v40, v96
  v_add_f32 v41, v41, v97
  v_add_f32 v42, v42, v98
L_c6:
  s_waitcnt vmcnt(0)
  v_cmp_ne_u32 vcc, v103, v39
  s_cbranch_vccnz L_c7
  s_bitset0_b32 s57, 7
  v_add_f32 v40, v40, v100
  v_add_f32 v41, v41, v101
  v_add_f32 v42, v42, v102
L_c7:
  buffer_load_dwordx4 v[104:107], v6, s[44:47], s37 offen offset:0 sc1
  buffer_load_dwordx4 v[108:111], v6, s[44:47], s37 offen offset:1024 sc1
  buffer_load_dwordx4 v[112:115], v6, s[44:47], s37 offen offset:2048 sc1
  buffer_load_dwordx4 v[116:119], v6, s[44:47], s37 offen offset:3072 sc1
  buffer_load_dwordx4 v[120:123], v6, s[44:47], s38 offen offset:0 sc1
  buffer_load_dwordx4 v[124:127], v6, s[44:47], s38 offen offset:1024 sc1
  buffer_load_dwordx4 v[128:131], v6, s[44:47], s38 offen offset:2048 sc1
L_f_g:
  s_barrier
  ds_read2st64_b32 v[44:45], v8 offset0:32 offset1:48
  ds_read2st64_b32 v[46:47], v8 offset0:64 offset1:80
  ds_read2st64_b32 v[48:49], v8 offset0:96 offset1:112
  ds_read2st64_b32 v[50:51], v8 offset0:128 offset1:144
  ds_read2st64_b32 v[52:53], v8 offset0:35 offset1:51
  ds_read2st64_b32 v[54:55], v8 offset0:67 offset1:83
  ds_read2st64_b32 v[56:57], v8 offset0:99 offset1:115
  ds_read2st64_b32 v[58:59], v8 offset0:131 offset1:147
  ds_read2st64_b32 v[60:61], v8 offset0:38 offset1:54
  ds_read2st64_b32 v[62:63], v8 offset0:70 offset1:86
  ds_read2st64_b32 v[64:65], v8 offset0:102 offset1:118
  ds_read2st64_b32 v[66:67], v8 offset0:134 offset1:150
  v_mov_b32 v15, v39
  s_waitcnt lgkmcnt(8)
  v_pk_add_f32 v[44:45], v[44:45], v[46:47]
  v_pk_add_f32 v[48:49], v[48:49], v[50:51]
  v_pk_add_f32 v[44:45], v[44:45], v[48:49]
  v_add_f32 v12, v44, v45
  s_waitcnt lgkmcnt(4)
  v_pk_add_f32 v[52:53], v[52:53], v[54:55]
  v_pk_add_f32 v[56:57], v[56:57], v[58:59]
  v_pk_add_f32 v[52:53], v[52:53], v[56:57]
  v_add_f32 v13, v52, v53
  s_waitcnt lgkmcnt(0)
  v_pk_add_f32 v[60:61], v[60:61], v[62:63]
  v_pk_add_f32 v[64:65], v[64:65], v[66:67]
  v_pk_add_f32 v[60:61], v[60:61], v[64:65]
  v_add_f32 v14, v60, v61
  s_cmp_eq_u32 s53, 15
  s_cbranch_scc1 L_f_red
  buffer_store_dwordx4 v[12:15], v6, s[44:47], s52 offen sc1
  s_branch L_done
L_f_red:
  v_add_f32 v12, v12, v40
  v_add_f32 v13, v13, v41
  v_add_f32 v14, v14, v42
  s_waitcnt vmcnt(6)
  v_cmp_ne_u32 vcc, v107, v39
  s_cbranch_vccnz L_c8
  s_bitset0_b32 s57, 8
  v_add_f32 v12, v12, v104
  v_add_f32 v13, v13, v105
  v_add_f32 v14, v14, v106
L_c8:
  s_waitcnt vmcnt(5)
  v_cmp_ne_u32 vcc, v111, v39
  s_cbranch_vccnz L_c9
  s_bitset0_b32 s57, 9
  v_add_f32 v12, v12, v108
  v_add_f32 v13, v13, v109
  v_add_f32 v14, v14, v110
L_c9:
  s_waitcnt vmcnt(4)
  v_cmp_ne_u32 vcc, v115, v39
  s_cbranch_vccnz L_c10
  s_bitset0_b32 s57, 10
  v_add_f32 v12, v12, v112
  v_add_f32 v13, v13, v113
  v_add_f32 v14, v14, v114
L_c10:
  s_waitcnt vmcnt(3)
  v_cmp_ne_u32 vcc, v119, v39
  s_cbranch_vccnz L_c11
  s_bitset0_b32 s57, 11
  v_add_f32 v12, v12, v116
  v_add_f32 v13, v13, v117
  v_add_f32 v14, v14, v118
L_c11:
  s_waitcnt vmcnt(2)
  v_cmp_ne_u32 vcc, v123, v39
  s_cbranch_vccnz L_c12
  s_bitset0_b32 s57, 12
  v_add_f32 v12, v12, v120
  v_add_f32 v13, v13, v121
  v_add_f32 v14, v14, v122
L_c12:
  s_waitcnt vmcnt(1)
  v_cmp_ne_u32 vcc, v127, v39
  s_cbranch_vccnz L_c13
  s_bitset0_b32 s57, 13
  v_add_f32 v12, v12, v124
  v_add_f32 v13, v13, v125
  v_add_f32 v14, v14, v126
L_c13:
  s_waitcnt vmcnt(0)
  v_cmp_ne_u32 vcc, v131, v39
  s_cbranch_vccnz L_c14
  s_bitset0_b32 s57, 14
  v_add_f32 v12, v12, v128
  v_add_f32 v13, v13, v129
  v_add_f32 v14, v14, v130
L_c14:
  s_cmp_eq_u32 s57, 0
  s_cbranch_scc1 L_f_out
  s_mov_b32 s54, s57
  s_and_b32 s54, s54, s57
  s_cselect_b32 s54, s54, s57
  s_ff1_i32_b32 s36, s54
  s_lshl_b32 s24, s36, 10
  s_bitset0_b32 s54, s36
  buffer_load_dwordx4 v[72:75], v6, s[44:47], s24 offen sc1
  s_and_b32 s54, s54, s57
  s_cselect_b32 s54, s54, s57
  s_ff1_i32_b32 s37, s54
  s_lshl_b32 s24, s37, 10
  s_bitset0_b32 s54, s37
  buffer_load_dwordx4 v[76:79], v6, s[44:47], s24 offen sc1
  s_and_b32 s54, s54, s57
  s_cselect_b32 s54, s54, s57
  s_ff1_i32_b32 s38, s54
  s_lshl_b32 s24, s38, 10
  s_bitset0_b32 s54, s38
  buffer_load_dwordx4 v[80:83], v6, s[44:47], s24 offen sc1
  s_and_b32 s54, s54, s57
  s_cselect_b32 s54, s54, s57
  s_ff1_i32_b32 s39, s54
  s_lshl_b32 s24, s39, 10
  s_bitset0_b32 s54, s39
  buffer_load_dwordx4 v[84:87], v6, s[44:47], s24 offen sc1
L_f_loop:
  s_waitcnt vmcnt(3)
  v_cmp_ne_u32 vcc, v75, v39
  s_bitcmp0_b32 s57, s36
  s_cbranch_scc1 L_d0
  s_cbranch_vccnz L_d0
  s_bitset0_b32 s57, s36
  v_add_f32 v12, v12, v72
  v_add_f32 v13, v13, v73
  v_add_f32 v14, v14, v74
  s_cmp_eq_u32 s57, 0
  s_cbranch_scc1 L_f_out
L_d0:
  s_and_b32 s54, s54, s57
  s_cselect_b32 s54, s54, s57
  s_ff1_i32_b32 s36, s54
  s_lshl_b32 s24, s36, 10
  s_bitset0_b32 s54, s36
  buffer_load_dwordx4 v[72:75], v6, s[44:47], s24 offen sc1
  s_waitcnt vmcnt(3)
  v_cmp_ne_u32 vcc, v79, v39
  s_bitcmp0_b32 s57, s37
  s_cbranch_scc1 L_d1
  s_cbranch_vccnz L_d1
  s_bitset0_b32 s57, s37
  v_add_f32 v12, v12, v76
  v_add_f32 v13, v13, v77
  v_add_f32 v14, v14, v78
  s_cmp_eq_u32 s57, 0
  s_cbranch_scc1 L_f_out
L_d1:
  s_and_b32 s54, s54, s57
  s_cselect_b32 s54, s54, s57
  s_ff1_i32_b32 s37, s54
  s_lshl_b32 s24, s37, 10
  s_bitset0_b32 s54, s37
  buffer_load_dwordx4 v[76:79], v6, s[44:47], s24 offen sc1
  s_waitcnt vmcnt(3)
  v_cmp_ne_u32 vcc, v83, v39
  s_bitcmp0_b32 s57, s38
  s_cbranch_scc1 L_d2
  s_cbranch_vccnz L_d2
  s_bitset0_b32 s57, s38
  v_add_f32 v12, v12, v80
  v_add_f32 v13, v13, v81
  v_add_f32 v14, v14, v82
  s_cmp_eq_u32 s57, 0
  s_cbranch_scc1 L_f_out
L_d2:
  s_and_b32 s54, s54, s57
  s_cselect_b32 s54, s54, s57
  s_ff1_i32_b32 s38, s54
  s_lshl_b32 s24, s38, 10
  s_bitset0_b32 s54, s38
  buffer_load_dwordx4 v[80:83], v6, s[44:47], s24 offen sc1
  s_waitcnt vmcnt(3)
  v_cmp_ne_u32 vcc, v87, v39
  s_bitcmp0_b32 s57, s39
  s_cbranch_scc1 L_d3
  s_cbranch_vccnz L_d3
  s_bitset0_b32 s57, s39
  v_add_f32 v12, v12, v84
  v_add_f32 v13, v13, v85
  v_add_f32 v14, v14, v86
  s_cmp_eq_u32 s57, 0
  s_cbranch_scc1 L_f_out
L_d3:
  s_and_b32 s54, s54, s57
  s_cselect_b32 s54, s54, s57
  s_ff1_i32_b32 s39, s54
  s_lshl_b32 s24, s39, 10
  s_bitset0_b32 s54, s39
  buffer_load_dwordx4 v[84:87], v6, s[44:47], s24 offen sc1
  s_sub_u32 s55, s55, 1
  s_cbranch_scc0 L_f_loop
L_f_out:
  v_cvt_pk_bf16_f32 v12, v12, v13
  v_cvt_pk_bf16_f32 v14, v14, v14
  buffer_store_short v12, v7, s[48:51], 0 offen
  buffer_store_short_d16_hi v12, v7, s[48:51], 0 offen offset:384
  buffer_store_short v14, v7, s[48:51], 0 offen offset:768
  s_branch L_done
L_q2:
  s_lshl_b32 s45, s20, 7
  s_add_u32 s45, s45, 4182016
  s_lshl_b32 s44, s21, 7
  s_add_u32 s44, s44, 4184064
  v_mov_b32 v8, s45
  v_writelane_b32 v8, s44, 1
  s_mov_b64 exec, 3
  global_load_dword v9, v8, s[18:19] sc1
  s_mov_b64 exec, -1
  s_mov_b32 s42, 0x05040100
  s_mov_b32 s43, 0x07060302
  s_lshl_b32 s44, s20, 16
  s_add_u32 s44, s44, 2097152
  s_add_u32 s32, s18, s44
  s_addc_u32 s33, s19, 0
  s_mov_b32 s34, 0x10000
  s_mov_b32 s35, 0x20000
  s_lshl_b32 s44, s36, 10
  s_lshl_b32 s45, s37, 8
  s_add_u32 s44, s44, s45
  v_lshl_add_u32 v10, v2, 4, s44
  v_lshl_add_u32 v10, v3, 14, v10
  s_lshl_b32 s45, s21, 12
  v_lshl_add_u32 v11, v0, 4, s45
  s_mov_b32 s50, 0x0c0c0400
  s_mov_b32 s51, 0x04000c0c
  s_mov_b32 s52, 0xffffff00
  s_mov_b32 s53, 0x7060500
  s_mov_b32 s54, 0x7060501
  s_mov_b32 s55, 0x7060502
  s_mov_b32 s56, 0x7060503
  v_mov_b32 v14, 0x80
  s_waitcnt vmcnt(33)
  v_perm_b32 v116, v46, v44, s42
  v_perm_b32 v117, v50, v48, s42
  v_perm_b32 v118, v54, v52, s42
  v_perm_b32 v119, v58, v56, s42
  v_perm_b32 v120, v46, v44, s43
  v_perm_b32 v121, v50, v48, s43
  v_perm_b32 v122, v54, v52, s43
  v_perm_b32 v123, v58, v56, s43
  v_perm_b32 v124, v47, v45, s42
  v_perm_b32 v125, v51, v49, s42
  v_perm_b32 v126, v55, v53, s42
  v_perm_b32 v127, v59, v57, s42
  v_perm_b32 v128, v47, v45, s43
  v_perm_b32 v129, v51, v49, s43
  v_perm_b32 v130, v55, v53, s43
  v_perm_b32 v131, v59, v57, s43
  s_nop 1
  v_mfma_f32_16x16x32_bf16 v[132:135], v[24:27], v[116:119], 0
  v_mfma_f32_16x16x32_bf16 v[136:139], v[24:27], v[120:123], 0
  v_mfma_f32_16x16x32_bf16 v[140:143], v[24:27], v[124:127], 0
  v_mfma_f32_16x16x32_bf16 v[144:147], v[24:27], v[128:131], 0
  s_waitcnt vmcnt(24)
  v_perm_b32 v116, v62, v60, s42
  v_perm_b32 v117, v66, v64, s42
  v_perm_b32 v118, v70, v68, s42
  v_perm_b32 v119, v74, v72, s42
  v_perm_b32 v120, v62, v60, s43
  v_perm_b32 v121, v66, v64, s43
  v_perm_b32 v122, v70, v68, s43
  v_perm_b32 v123, v74, v72, s43
  v_perm_b32 v124, v63, v61, s42
  v_perm_b32 v125, v67, v65, s42
  v_perm_b32 v126, v71, v69, s42
  v_perm_b32 v127, v75, v73, s42
  v_perm_b32 v128, v63, v61, s43
  v_perm_b32 v129, v67, v65, s43
  v_perm_b32 v130, v71, v69, s43
  v_perm_b32 v131, v75, v73, s43
  s_nop 1
  v_mfma_f32_16x16x32_bf16 v[132:135], v[28:31], v[116:119], v[132:135]
  v_mfma_f32_16x16x32_bf16 v[136:139], v[28:31], v[120:123], v[136:139]
  v_mfma_f32_16x16x32_bf16 v[140:143], v[28:31], v[124:127], v[140:143]
  v_mfma_f32_16x16x32_bf16 v[144:147], v[28:31], v[128:131], v[144:147]
  s_waitcnt vmcnt(15)
  v_perm_b32 v116, v78, v76, s42
  v_perm_b32 v117, v82, v80, s42
  v_perm_b32 v118, v86, v84, s42
  v_perm_b32 v119, v90, v88, s42
  v_perm_b32 v120, v78, v76, s43
  v_perm_b32 v121, v82, v80, s43
  v_perm_b32 v122, v86, v84, s43
  v_perm_b32 v123, v90, v88, s43
  v_perm_b32 v124, v79, v77, s42
  v_perm_b32 v125, v83, v81, s42
  v_perm_b32 v126, v87, v85, s42
  v_perm_b32 v127, v91, v89, s42
  v_perm_b32 v128, v79, v77, s43
  v_perm_b32 v129, v83, v81, s43
  v_perm_b32 v130, v87, v85, s43
  v_perm_b32 v131, v91, v89, s43
  s_nop 1
  v_mfma_f32_16x16x32_bf16 v[132:135], v[32:35], v[116:119], v[132:135]
  v_mfma_f32_16x16x32_bf16 v[136:139], v[32:35], v[120:123], v[136:139]
  v_mfma_f32_16x16x32_bf16 v[140:143], v[32:35], v[124:127], v[140:143]
  v_mfma_f32_16x16x32_bf16 v[144:147], v[32:35], v[128:131], v[144:147]
  s_waitcnt vmcnt(6)
  v_perm_b32 v116, v94, v92, s42
  v_perm_b32 v117, v98, v96, s42
  v_perm_b32 v118, v102, v100, s42
  v_perm_b32 v119, v106, v104, s42
  v_perm_b32 v120, v94, v92, s43
  v_perm_b32 v121, v98, v96, s43
  v_perm_b32 v122, v102, v100, s43
  v_perm_b32 v123, v106, v104, s43
  v_perm_b32 v124, v95, v93, s42
  v_perm_b32 v125, v99, v97, s42
  v_perm_b32 v126, v103, v101, s42
  v_perm_b32 v127, v107, v105, s42
  v_perm_b32 v128, v95, v93, s43
  v_perm_b32 v129, v99, v97, s43
  v_perm_b32 v130, v103, v101, s43
  v_perm_b32 v131, v107, v105, s43
  s_nop 1
  v_mfma_f32_16x16x32_bf16 v[132:135], v[36:39], v[116:119], v[132:135]
  v_mfma_f32_16x16x32_bf16 v[136:139], v[36:39], v[120:123], v[136:139]
  v_mfma_f32_16x16x32_bf16 v[140:143], v[36:39], v[124:127], v[140:143]
  v_mfma_f32_16x16x32_bf16 v[144:147], v[36:39], v[128:131], v[144:147]
  s_waitcnt vmcnt(1)
  v_perm_b32 v116, v110, v108, s42
  v_perm_b32 v117, v114, v112, s42
  v_perm_b32 v120, v110, v108, s43
  v_perm_b32 v121, v114, v112, s43
  v_perm_b32 v124, v111, v109, s42
  v_perm_b32 v125, v115, v113, s42
  v_perm_b32 v128, v111, v109, s43
  v_perm_b32 v129, v115, v113, s43
  s_nop 7
  v_mfma_f32_16x16x16_bf16 v[132:135], v[40:41], v[116:117], v[132:135]
  v_mfma_f32_16x16x16_bf16 v[136:139], v[40:41], v[120:121], v[136:139]
  v_mfma_f32_16x16x16_bf16 v[140:143], v[40:41], v[124:125], v[140:143]
  v_mfma_f32_16x16x16_bf16 v[144:147], v[40:41], v[128:129], v[144:147]
  s_waitcnt vmcnt(0)
  v_readlane_b32 s49, v9, 1
  v_and_b32 v12, 0x7f7f7f7f, v9
  v_and_b32 v13, 0x80808080, v9
  v_add_u32 v12, 0x01010101, v12
  v_xor_b32 v9, v12, v13
  s_nop 0
  v_readlane_b32 s46, v9, 0
  s_add_u32 s49, s49, 0x9e3779b9
  s_mov_b32 s41, 0
  s_nop 0
  v_mov_b32 v12, s46
  v_mov_b32 v13, s49
  v_perm_b32 v44, v132, v12, s53
  v_perm_b32 v45, v136, v12, s54
  v_perm_b32 v46, v140, v12, s55
  v_perm_b32 v47, v144, v12, s56
  buffer_store_dwordx4 v[44:47], v10, s[32:35], s41 offen sc1
  s_addk_i32 s41, 4096
  v_perm_b32 v48, v133, v12, s53
  v_perm_b32 v49, v137, v12, s54
  v_perm_b32 v50, v141, v12, s55
  v_perm_b32 v51, v145, v12, s56
  buffer_store_dwordx4 v[48:51], v10, s[32:35], s41 offen sc1
  s_addk_i32 s41, 4096
  v_perm_b32 v52, v134, v12, s53
  v_perm_b32 v53, v138, v12, s54
  v_perm_b32 v54, v142, v12, s55
  v_perm_b32 v55, v146, v12, s56
  buffer_store_dwordx4 v[52:55], v10, s[32:35], s41 offen sc1
  s_addk_i32 s41, 4096
  v_perm_b32 v56, v135, v12, s53
  v_perm_b32 v57, v139, v12, s54
  v_perm_b32 v58, v143, v12, s55
  v_perm_b32 v59, v147, v12, s56
  buffer_store_dwordx4 v[56:59], v10, s[32:35], s41 offen sc1
  v_mov_b32 v16, 0
  v_lshlrev_b32 v15, 2, v0
  ds_write_b32 v15, v16 offset:512
  ds_write_b32 v16, v13 offset:512
  s_waitcnt vmcnt(0)
  s_mov_b32 s47, 1000000
L_poll:
  s_sleep 16
  s_sub_u32 s47, s47, 1
  s_cbranch_scc1 L_pollx
  buffer_load_dwordx4 v[80:83], v11, s[32:35], 0 offen offset:0 sc1
  buffer_load_dwordx4 v[84:87], v11, s[32:35], 0 offen offset:1024 sc1
  buffer_load_dwordx4 v[88:91], v11, s[32:35], 0 offen offset:2048 sc1
  buffer_load_dwordx4 v[92:95], v11, s[32:35], 0 offen offset:3072 sc1
  s_waitcnt vmcnt(0)
  v_perm_b32 v16, v81, v80, s50
  v_perm_b32 v17, v83, v82, s51
  v_or_b32 v16, v16, v17
  v_cmpx_eq_u32 vcc, s46, v16
  v_perm_b32 v16, v85, v84, s50
  v_perm_b32 v17, v87, v86, s51
  v_or_b32 v16, v16, v17
  v_cmpx_eq_u32 vcc, s46, v16
  v_perm_b32 v16, v89, v88, s50
  v_perm_b32 v17, v91, v90, s51
  v_or_b32 v16, v16, v17
  v_cmpx_eq_u32 vcc, s46, v16
  v_perm_b32 v16, v93, v92, s50
  v_perm_b32 v17, v95, v94, s51
  v_or_b32 v16, v16, v17
  v_cmpx_eq_u32 vcc, s46, v16
  s_nop 1
  s_cmp_eq_u64 exec, -1
  s_mov_b64 exec, -1
  s_cbranch_scc0 L_poll
L_pollx:
  v_and_or_b32 v80, v80, s52, v14
  v_and_or_b32 v81, v81, s52, v14
  v_and_or_b32 v82, v82, s52, v14
  v_and_or_b32 v83, v83, s52, v14
  v_and_or_b32 v84, v84, s52, v14
  v_and_or_b32 v85, v85, s52, v14
  v_and_or_b32 v86, v86, s52, v14
  v_and_or_b32 v87, v87, s52, v14
  v_and_or_b32 v88, v88, s52, v14
  v_and_or_b32 v89, v89, s52, v14
  v_and_or_b32 v90, v90, s52, v14
  v_and_or_b32 v91, v91, s52, v14
  v_and_or_b32 v92, v92, s52, v14
  v_and_or_b32 v93, v93, s52, v14
  v_and_or_b32 v94, v94, s52, v14
  v_and_or_b32 v95, v95, s52, v14
  v_add_f32 v80, v80, v84
  v_add_f32 v88, v88, v92
  v_add_f32 v81, v81, v85
  v_add_f32 v89, v89, v93
  v_add_f32 v82, v82, v86
  v_add_f32 v90, v90, v94
  v_add_f32 v83, v83, v87
  v_add_f32 v91, v91, v95
  v_add_f32 v80, v80, v88
  v_add_f32 v81, v81, v89
  v_add_f32 v82, v82, v90
  v_add_f32 v83, v83, v91
  v_cvt_pk_bf16_f32 v16, v80, v81
  v_cvt_pk_bf16_f32 v17, v82, v83
  v_lshlrev_b32 v2, 3, v0
  ds_write_b64 v2, v[16:17] offset:0
  s_cmp_lg_u32 s21, 0
  s_cbranch_scc1 L_noep
  s_mov_b64 exec, 1
  global_store_dword v8, v12, s[18:19] sc1
  s_mov_b64 exec, -1
L_noep:
  s_setprio 0
  s_branch L_h_wait1
L_helper:
  s_sub_u32 s23, s3, 4
  s_cmp_lg_u32 s23, 1
  s_cbranch_scc1 L_h_wait1
  s_lshl_b32 s36, s21, 4
  s_add_u32 s36, s36, s20
  s_lshl_b32 s36, s36, 20
  v_mov_b32 v4, s36
  s_mul_i32 s37, s20, 294912
  v_mov_b32 v5, s37
  v_add_u32 v7, 294784, v5
  v_mov_b32 v6, 0
  s_mov_b64 exec, 1
  s_waitcnt lgkmcnt(0)
  global_load_dword v8, v4, s[8:9] nt
  s_mov_b64 exec, -1
  s_waitcnt vmcnt(0)
L_h_wait1:
  s_waitcnt lgkmcnt(0)
  s_barrier
  s_lshl_b32 s36, s20, 8
  s_lshl_b32 s39, s21, 4
  s_add_u32 s38, s36, s39
  s_mul_i32 s38, s38, 1152
  s_mul_i32 s39, s23, 2304
  s_add_u32 s38, s38, s39
  v_lshl_add_u32 v4, v0, 6, s38
  s_mov_b32 exec_hi, 15
  global_load_dword v5, v4, s[12:13]
  s_mov_b64 exec, -1
  s_cmp_lg_u32 s23, 1
  s_cbranch_scc1 L_nopre
  s_lshl_b32 s38, s21, 16
  s_lshl_b32 s39, s20, 10
  s_add_u32 s38, s38, s39
  s_add_u32 s38, s38, 3145728
  v_and_b32 v4, 7, v0
  v_lshl_add_u32 v4, v4, 7, s38
  v_lshrrev_b32 v6, 3, v0
  v_lshl_add_u32 v4, v6, 14, v4
  s_mov_b64 exec, 0xffffff
  global_load_dword v6, v4, s[18:19] sc1
  s_mov_b64 exec, -1
L_nopre:
  s_lshl_b32 s37, s23, 5
  s_add_u32 s36, s36, s37
  s_mul_i32 s36, s36, 1152
  s_add_u32 s24, s12, s36
  s_addc_u32 s25, s13, 0
  s_mov_b32 s26, 36864
  v_lshrrev_b32 v3, 4, v0
  v_mul_u32_u24 v1, 1152, v3
  v_bfe_u32 v3, v0, 3, 1
  v_mul_u32_u24 v2, 9216, v3
  v_add_u32 v2, v2, v1
  v_and_b32 v3, 7, v0
  v_lshl_add_u32 v2, v3, 4, v2
  v_and_b32 v3, 15, v0
  v_lshl_add_u32 v1, v3, 4, v1
  s_waitcnt vmcnt(0)
  s_movk_i32 s39, 0
  buffer_load_dwordx4 v[24:27], v2, s[24:27], s39 offen offset:1024 nt
  s_waitcnt vmcnt(0)
  s_movk_i32 s39, 4608
  buffer_load_dwordx4 v[28:31], v2, s[24:27], s39 offen offset:1024 nt
  s_waitcnt vmcnt(0)
  s_movk_i32 s39, 18432
  buffer_load_dwordx4 v[32:35], v2, s[24:27], s39 offen offset:1024 nt
  s_waitcnt vmcnt(0)
  s_movk_i32 s39, 23040
  buffer_load_dwordx4 v[36:39], v2, s[24:27], s39 offen offset:1024 nt
  s_waitcnt vmcnt(0)
  s_cmp_eq_u32 s23, 0
  s_cselect_b64 vcc, -1, 0
  s_mov_b32 s39, 0
  buffer_load_dwordx4 v[40:43], v1, s[24:27], s39 offen offset:0 nt
  s_waitcnt vmcnt(0)
  buffer_load_dwordx4 v[48:51], v1, s[24:27], s39 offen offset:256 nt
  s_waitcnt vmcnt(0)
  buffer_load_dwordx4 v[56:59], v1, s[24:27], s39 offen offset:512 nt
  s_waitcnt vmcnt(0)
  buffer_load_dwordx4 v[64:67], v1, s[24:27], s39 offen offset:768 nt
  s_waitcnt vmcnt(0)
  s_addk_i32 s39, 4608
  buffer_load_dwordx4 v[44:47], v1, s[24:27], s39 offen offset:0 nt
  s_waitcnt vmcnt(0)
  buffer_load_dwordx4 v[52:55], v1, s[24:27], s39 offen offset:256 nt
  s_waitcnt vmcnt(0)
  buffer_load_dwordx4 v[60:63], v1, s[24:27], s39 offen offset:512 nt
  s_waitcnt vmcnt(0)
  buffer_load_dwordx4 v[68:71], v1, s[24:27], s39 offen offset:768 nt
  s_waitcnt vmcnt(0)
  s_addk_i32 s39, 4608
  buffer_load_dwordx4 v[72:75], v1, s[24:27], s39 offen offset:0 nt
  s_waitcnt vmcnt(0)
  buffer_load_dwordx4 v[80:83], v1, s[24:27], s39 offen offset:256 nt
  s_waitcnt vmcnt(0)
  buffer_load_dwordx4 v[88:91], v1, s[24:27], s39 offen offset:512 nt
  s_waitcnt vmcnt(0)
  buffer_load_dwordx4 v[96:99], v1, s[24:27], s39 offen offset:768 nt
  s_waitcnt vmcnt(0)
  s_addk_i32 s39, 4608
  buffer_load_dwordx4 v[76:79], v1, s[24:27], s39 offen offset:0 nt
  s_waitcnt vmcnt(0)
  buffer_load_dwordx4 v[84:87], v1, s[24:27], s39 offen offset:256 nt
  s_waitcnt vmcnt(0)
  buffer_load_dwordx4 v[92:95], v1, s[24:27], s39 offen offset:512 nt
  s_waitcnt vmcnt(0)
  buffer_load_dwordx4 v[100:103], v1, s[24:27], s39 offen offset:768 nt
  s_waitcnt vmcnt(0)
  s_addk_i32 s39, 4608
  buffer_load_dwordx4 v[104:107], v1, s[24:27], s39 offen offset:0 nt
  s_waitcnt vmcnt(0)
  buffer_load_dwordx4 v[112:115], v1, s[24:27], s39 offen offset:256 nt
  s_waitcnt vmcnt(0)
  buffer_load_dwordx4 v[120:123], v1, s[24:27], s39 offen offset:512 nt
  s_waitcnt vmcnt(0)
  buffer_load_dwordx4 v[128:131], v1, s[24:27], s39 offen offset:768 nt
  s_waitcnt vmcnt(0)
  s_addk_i32 s39, 4608
  buffer_load_dwordx4 v[108:111], v1, s[24:27], s39 offen offset:0 nt
  s_waitcnt vmcnt(0)
  buffer_load_dwordx4 v[116:119], v1, s[24:27], s39 offen offset:256 nt
  s_waitcnt vmcnt(0)
  buffer_load_dwordx4 v[124:127], v1, s[24:27], s39 offen offset:512 nt
  s_waitcnt vmcnt(0)
  buffer_load_dwordx4 v[132:135], v1, s[24:27], s39 offen offset:768 nt
  s_waitcnt vmcnt(0)
  s_addk_i32 s39, 4608
  buffer_load_dwordx4 v[136:139], v1, s[24:27], s39 offen offset:0 nt
  s_waitcnt vmcnt(0)
  buffer_load_dwordx4 v[144:147], v1, s[24:27], s39 offen offset:256 nt
  s_waitcnt vmcnt(0)
  buffer_load_dwordx4 v[152:155], v1, s[24:27], s39 offen offset:512 nt
  s_waitcnt vmcnt(0)
  buffer_load_dwordx4 v[160:163], v1, s[24:27], s39 offen offset:768 nt
  s_waitcnt vmcnt(0)
  s_addk_i32 s39, 4608
  buffer_load_dwordx4 v[140:143], v1, s[24:27], s39 offen offset:0 nt
  s_waitcnt vmcnt(0)
  buffer_load_dwordx4 v[148:151], v1, s[24:27], s39 offen offset:256 nt
  s_waitcnt vmcnt(0)
  buffer_load_dwordx4 v[156:159], v1, s[24:27], s39 offen offset:512 nt
  s_waitcnt vmcnt(0)
  buffer_load_dwordx4 v[164:167], v1, s[24:27], s39 offen offset:768 nt
  s_waitcnt vmcnt(0)
  s_cmp_lg_u32 s23, 0
  s_cbranch_scc1 L_ctl_end
  s_lshl_b32 s36, s20, 7
  s_add_u32 s36, s36, 4177920
  s_add_u32 s32, s18, s36
  s_addc_u32 s33, s19, 0
  s_lshl_b32 s36, s21, 2
  v_mov_b32 v4, s36
  v_lshlrev_b32 v5, 2, v0
  v_mov_b32 v6, 0
  s_mov_b32 s35, 0
  s_mov_b64 exec, 0xffff
L_ctl:
  s_sleep 2
  ds_read_b32 v7, v6 offset:544
  s_waitcnt lgkmcnt(0)
  v_readfirstlane_b32 s36, v7
  s_cmp_eq_u32 s36, s35
  s_cbranch_scc1 L_ctl
  s_mov_b32 s35, s36
  s_cmp_ge_u32 s36, 54
  s_cbranch_scc1 L_ctl_x
  global_load_dword v8, v5, s[32:33] nt
  v_add_u32 v7, s46, v7
  s_mov_b64 exec, 1
  global_store_dword v4, v7, s[32:33]
  s_mov_b64 exec, 0xffff
  s_waitcnt vmcnt(1)
  v_sub_u32 v8, v8, v7
  v_cmp_gt_u32 vcc, 64, v8
  s_mov_b32 s37, 0
  s_bcnt1_i32_b64 s38, vcc
  s_cmp_ge_u32 s38, 13
  s_cselect_b32 s37, 3, s37
  s_cmp_eq_u32 s37, 0
  s_cbranch_scc1 L_ctl
  s_add_u32 s37, s37, s36
  v_mov_b32 v8, s37
  s_mov_b64 exec, 15
  ds_write_b32 v5, v8 offset:528
  s_mov_b64 exec, 0xffff
  s_branch L_ctl
L_ctl_x:
  s_mov_b64 exec, -1
L_ctl_end:
  s_cmp_lg_u32 s23, 3
  s_cbranch_scc1 L_n_end
  v_and_b32 v5, 3, v0
  v_lshlrev_b32 v5, 2, v5
L_n_wait:
  s_sleep 8
  ds_read_b32 v6, v5 offset:544
  s_waitcnt lgkmcnt(0)
  v_cmp_gt_u32 vcc, 32, v6
  s_cbranch_vccnz L_n_wait
  v_lshlrev_b32 v5, 4, v0
  v_mov_b32 v6, 0xff7fffff
  s_mov_b32 s36, 0
L_n_max:
  ds_read_b128 v[8:11], v5 offset:8192
  ds_read_b128 v[12:15], v5 offset:9216
  v_add_u32 v5, 2048, v5
  s_add_u32 s36, s36, 1
  s_cmp_lt_u32 s36, 16
  s_waitcnt lgkmcnt(0)
  v_max3_f32 v6, v6, v8, v9
  v_max3_f32 v6, v6, v10, v11
  v_max3_f32 v6, v6, v12, v13
  v_max3_f32 v6, v6, v14, v15
  s_cbranch_scc1 L_n_max
  s_nop 1
  v_max_f32_dpp v6, v6, v6 quad_perm:[1,0,3,2] row_mask:0xf bank_mask:0xf
  s_nop 1
  v_max_f32_dpp v6, v6, v6 row_ror:4 row_mask:0xf bank_mask:0xf
  s_nop 1
  v_max_f32_dpp v6, v6, v6 row_ror:8 row_mask:0xf bank_mask:0xf
  v_mov_b32 v7, v6
  s_nop 1
  v_permlane16_swap_b32 v6, v7
  s_nop 1
  v_max_f32 v6, v6, v7
  v_mov_b32 v7, v6
  s_nop 1
  v_permlane32_swap_b32 v6, v7
  s_nop 1
  v_max_f32 v6, v6, v7
  v_mul_f32 v6, s40, v6
  v_lshlrev_b32 v5, 4, v0
  v_mov_b32 v4, 0
  s_mov_b32 s36, 0
L_n_sum:
  ds_read_b128 v[8:11], v5 offset:8192
  ds_read_b128 v[12:15], v5 offset:9216
  v_add_u32 v5, 2048, v5
  s_add_u32 s36, s36, 1
  s_cmp_lt_u32 s36, 16
  s_waitcnt lgkmcnt(0)
  v_fma_f32 v8, v8, s40, -v6
  v_fma_f32 v9, v9, s40, -v6
  v_fma_f32 v10, v10, s40, -v6
  v_fma_f32 v11, v11, s40, -v6
  v_fma_f32 v12, v12, s40, -v6
  v_fma_f32 v13, v13, s40, -v6
  v_fma_f32 v14, v14, s40, -v6
  v_fma_f32 v15, v15, s40, -v6
  v_exp_f32 v8, v8
  v_exp_f32 v9, v9
  v_exp_f32 v10, v10
  v_exp_f32 v11, v11
  v_exp_f32 v12, v12
  v_exp_f32 v13, v13
  v_exp_f32 v14, v14
  v_exp_f32 v15, v15
  s_nop 0
  v_add_f32 v8, v8, v12
  v_add_f32 v9, v9, v13
  v_add_f32 v10, v10, v14
  v_add_f32 v11, v11, v15
  v_add_f32 v8, v8, v9
  v_add_f32 v10, v10, v11
  v_add_f32 v8, v8, v10
  v_add_f32 v4, v4, v8
  s_cbranch_scc1 L_n_sum
  s_nop 1
  v_add_f32_dpp v4, v4, v4 quad_perm:[1,0,3,2] row_mask:0xf bank_mask:0xf
  s_nop 1
  v_add_f32_dpp v4, v4, v4 row_ror:4 row_mask:0xf bank_mask:0xf
  s_nop 1
  v_add_f32_dpp v4, v4, v4 row_ror:8 row_mask:0xf bank_mask:0xf
  v_mov_b32 v7, v4
  s_nop 1
  v_permlane16_swap_b32 v4, v7
  s_nop 1
  v_add_f32 v4, v4, v7
  v_mov_b32 v7, v4
  s_nop 1
  v_permlane32_swap_b32 v4, v7
  s_nop 1
  v_add_f32 v4, v4, v7
  v_log_f32 v4, v4
  v_and_b32 v5, 2, v0
  v_lshlrev_b32 v5, 2, v5
  v_add_f32 v6, v6, v4
  v_mov_b32 v7, 1
  ds_write_b64 v5, v[6:7] offset:560
  s_waitcnt lgkmcnt(0)
L_n_end:
  s_waitcnt vmcnt(0)
  v_bfe_u32 v4, v0, 2, 1
  v_cmp_eq_u32 vcc, 0, v4
  v_mov_b32 v5, 0xffff
  v_bfe_u32 v6, v0, 3, 1
  v_cmp_eq_u32 s[42:43], 1, v6
  v_cndmask_b32 v12, 0, v5, vcc
  v_xor_b32 v13, v12, v5
  v_lshlrev_b32 v14, 16, v12
  v_lshlrev_b32 v15, 16, v13
  s_lshl_b32 s36, s23, 7
  s_add_u32 s36, s36, 1024
  v_lshrrev_b32 v7, 4, v0
  v_lshl_add_u32 v1, v7, 3, s36
  v_bfe_u32 v7, v0, 2, 2
  v_mul_u32_u24 v7, 1168, v7
  v_add_u32 v1, v1, v7
  v_and_b32 v7, 3, v0
  v_lshl_add_u32 v1, v7, 5, v1
  s_lshl_b32 s36, s23, 12
  v_bfe_u32 v8, v0, 4, 1
  v_lshl_add_u32 v8, v8, 4, s36
  v_lshrrev_b32 v9, 5, v0
  v_and_b32 v10, 15, v0
  v_lshl_add_u32 v8, v10, 5, v8
  v_lshl_add_u32 v2, v9, 9, v8
  v_and_b32 v10, 40, v0
  v_cmp_eq_u32 vcc, 0, v10
  v_add_u32 v3, 2048, v8
  v_add_u32 v8, 3072, v8
  v_and_b32 v4, 3, v0
  v_cndmask_b32 v3, v8, v3, vcc
  v_mul_u32_u24 v0, 0x5555, v4
  v_mov_b32 v20, 0
  v_mov_b32 v21, 0
  v_mov_b32 v22, 0
  v_mov_b32 v23, 0
  s_mov_b32 s44, 0
  s_mov_b32 s45, -1
  s_barrier
  ds_read_b64 v[4:5], v1
  s_waitcnt lgkmcnt(0)
  v_add_f32_dpp v4, v4, v4 row_ror:4 row_mask:0xf bank_mask:0xf
  v_add_f32_dpp v5, v5, v5 row_ror:4 row_mask:0xf bank_mask:0xf
  s_nop 0
  v_add_f32_dpp v4, v4, v4 row_ror:8 row_mask:0xf bank_mask:0xf
  v_add_f32_dpp v5, v5, v5 row_ror:8 row_mask:0xf bank_mask:0xf
  v_cvt_pk_bf16_f32 v4, v4, v5
  s_nop 1
  v_mov_b32_dpp v6, v4 quad_perm:[0,0,0,0] row_mask:0xf bank_mask:0x3
  v_mov_b32_dpp v7, v4 quad_perm:[2,2,2,2] row_mask:0xf bank_mask:0x3
  s_nop 0
  v_mov_b32_dpp v6, v4 quad_perm:[1,1,1,1] row_mask:0xf bank_mask:0xc
  v_mov_b32_dpp v7, v4 quad_perm:[3,3,3,3] row_mask:0xf bank_mask:0xc
  v_and_b32 v16, v12, v6
  v_and_b32 v17, v13, v6
  v_and_b32 v18, v14, v6
  v_and_b32 v19, v15, v6
  v_and_b32 v8, v12, v7
  v_and_b32 v9, v13, v7
  v_smfmac_f32_16x16x64_bf16 v[20:23], v[16:19], v[24:31], v0
  v_and_b32 v10, v14, v7
  v_and_b32 v11, v15, v7
  v_and_b32_dpp v16, v4, v12 quad_perm:[0,0,0,0] row_mask:0xf bank_mask:0xf
  v_and_b32_dpp v17, v4, v13 quad_perm:[0,0,0,0] row_mask:0xf bank_mask:0xf
  v_smfmac_f32_16x16x64_bf16 v[20:23], v[8:11], v[32:39], v0
  v_and_b32_dpp v18, v4, v14 quad_perm:[0,0,0,0] row_mask:0xf bank_mask:0xf
  v_and_b32_dpp v19, v4, v15 quad_perm:[0,0,0,0] row_mask:0xf bank_mask:0xf
  v_mov_b32 v24, 0
  v_mov_b32 v25, 0
  v_mov_b32 v26, 0
  v_mov_b32 v27, 0
  v_mov_b32 v28, 0
  v_mov_b32 v29, 0
  v_smfmac_f32_16x16x64_bf16 v[24:27], v[16:19], v[40:47], v0
  v_mov_b32 v30, 0
  v_mov_b32 v31, 0
  v_mov_b32 v32, 0
  v_mov_b32 v33, 0
  v_smfmac_f32_16x16x64_bf16 v[28:31], v[16:19], v[48:55], v0
  v_mov_b32 v34, 0
  v_mov_b32 v35, 0
  v_mov_b32 v36, 0
  v_mov_b32 v37, 0
  v_smfmac_f32_16x16x64_bf16 v[32:35], v[16:19], v[56:63], v0
  v_mov_b32 v38, 0
  v_mov_b32 v39, 0
  v_and_b32_dpp v8, v4, v12 quad_perm:[1,1,1,1] row_mask:0xf bank_mask:0xf
  v_and_b32_dpp v9, v4, v13 quad_perm:[1,1,1,1] row_mask:0xf bank_mask:0xf
  v_smfmac_f32_16x16x64_bf16 v[36:39], v[16:19], v[64:71], v0
  v_and_b32_dpp v10, v4, v14 quad_perm:[1,1,1,1] row_mask:0xf bank_mask:0xf
  v_and_b32_dpp v11, v4, v15 quad_perm:[1,1,1,1] row_mask:0xf bank_mask:0xf
  s_nop 1
  v_smfmac_f32_16x16x64_bf16 v[24:27], v[8:11], v[72:79], v0
  v_and_b32_dpp v16, v4, v12 quad_perm:[2,2,2,2] row_mask:0xf bank_mask:0xf
  v_and_b32_dpp v17, v4, v13 quad_perm:[2,2,2,2] row_mask:0xf bank_mask:0xf
  v_smfmac_f32_16x16x64_bf16 v[28:31], v[8:11], v[80:87], v0
  v_and_b32_dpp v18, v4, v14 quad_perm:[2,2,2,2] row_mask:0xf bank_mask:0xf
  v_and_b32_dpp v19, v4, v15 quad_perm:[2,2,2,2] row_mask:0xf bank_mask:0xf
  v_smfmac_f32_16x16x64_bf16 v[32:35], v[8:11], v[88:95], v0
  v_mov_b32 v40, v20
  v_mov_b32 v41, v21
  v_smfmac_f32_16x16x64_bf16 v[36:39], v[8:11], v[96:103], v0
  v_mov_b32 v42, v22
  v_mov_b32 v43, v23
  v_smfmac_f32_16x16x64_bf16 v[24:27], v[16:19], v[104:111], v0
  v_and_b32_dpp v8, v4, v12 quad_perm:[3,3,3,3] row_mask:0xf bank_mask:0xf
  v_and_b32_dpp v9, v4, v13 quad_perm:[3,3,3,3] row_mask:0xf bank_mask:0xf
  v_smfmac_f32_16x16x64_bf16 v[28:31], v[16:19], v[112:119], v0
  v_and_b32_dpp v10, v4, v14 quad_perm:[3,3,3,3] row_mask:0xf bank_mask:0xf
  v_and_b32_dpp v11, v4, v15 quad_perm:[3,3,3,3] row_mask:0xf bank_mask:0xf
  v_smfmac_f32_16x16x64_bf16 v[32:35], v[16:19], v[120:127], v0
  v_permlane32_swap_b32 v20, v40
  v_permlane32_swap_b32 v21, v41
  v_smfmac_f32_16x16x64_bf16 v[36:39], v[16:19], v[128:135], v0
  v_permlane32_swap_b32 v22, v42
  v_permlane32_swap_b32 v23, v43
  v_smfmac_f32_16x16x64_bf16 v[24:27], v[8:11], v[136:143], v0
  v_smfmac_f32_16x16x64_bf16 v[28:31], v[8:11], v[144:151], v0
  v_add_f32_dpp v20, v40, v20 row_ror:8 row_mask:0xf bank_mask:0xf
  v_add_f32_dpp v21, v41, v21 row_ror:8 row_mask:0xf bank_mask:0xf
  v_smfmac_f32_16x16x64_bf16 v[32:35], v[8:11], v[152:159], v0
  v_add_f32_dpp v22, v42, v22 row_ror:8 row_mask:0xf bank_mask:0xf
  v_add_f32_dpp v23, v43, v23 row_ror:8 row_mask:0xf bank_mask:0xf
  v_smfmac_f32_16x16x64_bf16 v[36:39], v[8:11], v[160:167], v0
  ds_write_b128 v3, v[20:23] offset:8192
  s_nop 3
  v_cndmask_b32 v4, v24, v28, s[44:45]
  v_cndmask_b32 v5, v25, v29, s[44:45]
  v_cndmask_b32 v6, v26, v30, s[44:45]
  v_cndmask_b32 v7, v27, v31, s[44:45]
  ds_write_b128 v2, v[4:7] offset:8192
  v_cndmask_b32 v8, v32, v36, s[44:45]
  v_cndmask_b32 v9, v33, v37, s[44:45]
  v_cndmask_b32 v10, v34, v38, s[44:45]
  v_cndmask_b32 v11, v35, v39, s[44:45]
  ds_write_b128 v2, v[8:11] offset:9216
  s_waitcnt lgkmcnt(0)
  s_barrier
L_done:
L_end:
  s_endpgm
.section .rodata,"a"
.p2align 6
.amdhsa_kernel standalone__gqa_block_cached__sampling_kernel
  .amdhsa_next_free_vgpr 168
  .amdhsa_next_free_sgpr 64
  .amdhsa_accum_offset 168
  .amdhsa_group_segment_fixed_size 0
  .amdhsa_kernarg_size 64
  .amdhsa_user_sgpr_count 2
  .amdhsa_user_sgpr_kernarg_segment_ptr 1
  .amdhsa_system_sgpr_workgroup_id_x 1
.end_amdhsa_kernel
```
